```python
import torch

def _softmax(x, axis=-1):
    return torch.softmax(x, dim=axis)
def _gelu(x):
    return torch.nn.functional.gelu(x, approximate="tanh")
def _silu(x):
    return torch.nn.functional.silu(x)
def _sigmoid(x):
    return torch.sigmoid(x)
def _layernorm(x, axis=-1, eps=1e-5):
    m = x.mean(dim=axis, keepdim=True)
    v = x.var(dim=axis, keepdim=True, unbiased=False)
    return (x - m) / torch.sqrt(v + eps)
def _scatter_add(tgt, idx, src, axis=0):
    return tgt.clone().index_add_(axis, idx, src)
def _segment_sum(src, seg, n):
    out = torch.zeros((n,) + src.shape[1:], dtype=src.dtype)
    return out.index_add_(0, seg, src)
def _pad(x, pw):
    flat = tuple(v for pair in reversed(pw) for v in pair)
    return torch.nn.functional.pad(x, flat)

kernel_name = 'gated_mix__mha_block_cached__glu_gated_geglu__decode'

def setup_inputs():

    _w = (lambda a: (lambda t: t.to(torch.bfloat16) if t.is_floating_point() else t)(torch.as_tensor(a)))
    def _A_setup():
        B, Sq, D = 8, 1, 576
        H, Sk, Dh = 32, 4096, 128
        return {
            "x": _w((lambda *s: torch.randn(*s, dtype=torch.bfloat16) * 0.05)(B, Sq, D)),
            "k_cache": _w((lambda *s: torch.randn(*s, dtype=torch.bfloat16) * 3.2)(B, H, Sk, Dh)),
            "v_cache": _w((lambda *s: torch.randn(*s, dtype=torch.bfloat16) * 0.05)(B, H, Sk, Dh)),
            "wq": _w((lambda *s: torch.randn(*s, dtype=torch.bfloat16) * 3.2)(D, H * Dh) * (D ** -0.5)),
            "wo": _w((lambda *s: torch.randn(*s, dtype=torch.bfloat16) * 0.05)(H * Dh, D) * ((H * Dh) ** -0.5)),
        }
    _A_in = _A_setup()

    def _B_setup():
        B, S, Dm, Df = 8, 1, 576, 4608
        return {
            "x": _w((lambda *s: torch.randn(*s, dtype=torch.bfloat16) * 0.05)(B, S, Dm)),
            "w_gate": _w((lambda *s: torch.randn(*s, dtype=torch.bfloat16) * 0.2)(Dm, Df) * (Dm ** -0.5)),
            "w_up": _w((lambda *s: torch.randn(*s, dtype=torch.bfloat16) * 0.2)(Dm, Df) * (Dm ** -0.5)),
            "w_down": _w((lambda *s: torch.randn(*s, dtype=torch.bfloat16) * 0.2)(Df, Dm) * (Df ** -0.5)),
        }
    _B_in = _B_setup()

    return {
        "A_x": _A_in["x"],
        "A_k_cache": _A_in["k_cache"],
        "A_v_cache": _A_in["v_cache"],
        "A_wq": _A_in["wq"],
        "A_wo": _A_in["wo"],
        "B_x": _B_in["x"],
        "B_w_gate": _B_in["w_gate"],
        "B_w_up": _B_in["w_up"],
        "B_w_down": _B_in["w_down"],
        "gate_w": _w((lambda *s: torch.randn(*s, dtype=torch.bfloat16) * 0.05)(576) * 16.0),
    }

def reference(A_x, A_k_cache, A_v_cache, A_wq, A_wo, B_x, B_w_gate, B_w_up, B_w_down, gate_w):
    def _A_ref(x, k_cache, v_cache, wq, wo):
        B, Sq, D = x.shape
        H, Dh = 32, 128
        q = (lambda x, *d: x.permute(*d))((x @ wq).reshape(B, Sq, H, Dh), 0, 2, 1, 3)
        scores = torch.einsum("bhqd,bhkd->bhqk", q, k_cache) * (Dh ** -0.5)
        p = _softmax(scores, axis=-1)
        o = torch.einsum("bhqk,bhkd->bhqd", p, v_cache)
        return (lambda x, *d: x.permute(*d))(o, 0, 2, 1, 3).reshape(B, Sq, H * Dh) @ wo

    def _B_ref(x, w_gate, w_up, w_down):
        g = torch.einsum("bsd,df->bsf", x, w_gate)
        u = torch.einsum("bsd,df->bsf", x, w_up)
        h = _gelu(g) * u
        return torch.einsum("bsf,fd->bsd", h, w_down)

    x = A_x
    g = _sigmoid((x * gate_w).sum(-1, keepdims=True))
    a = _A_ref(x, A_k_cache, A_v_cache, A_wq, A_wo)
    b = _B_ref(x, B_w_gate, B_w_up, B_w_down)
    return g * a + (1 - g) * b
```

```asm
; @launch grid=(256,1,1) block=(1024,1,1) lds=124160
.amdgcn_target "amdgcn-amd-amdhsa--gfx950"
.text
.globl gated_mix__mha_block_cached__glu_gated_geglu__decode_kernel
.p2align 8
.type gated_mix__mha_block_cached__glu_gated_geglu__decode_kernel,@function
gated_mix__mha_block_cached__glu_gated_geglu__decode_kernel:
  s_cmp_ge_u32 s2, 256
  s_cbranch_scc1 L_end
  s_load_dwordx16 s[76:91], s[0:1], 0
  s_load_dwordx8 s[92:99], s[0:1], 64
  s_load_dwordx2 s[100:101], s[0:1], 96
  v_lshrrev_b32 v44, 6, v0
  v_and_b32 v45, 63, v0
  v_readfirstlane_b32 s56, v44
  v_lshlrev_b32 v1, 4, v45
  v_lshrrev_b32 v46, 4, v45
  v_and_b32 v47, 15, v45
  v_lshlrev_b32 v48, 4, v47
  v_lshl_add_u32 v2, v46, 13, v48
  v_mul_u32_u24 v49, 9216, v46
  v_add_u32 v3, v49, v48
  v_lshrrev_b32 v49, 1, v47
  v_lshl_add_u32 v50, v49, 2, v46
  v_and_b32 v51, 1, v47
  v_lshlrev_b32 v51, 4, v51
  v_mul_u32_u24 v4, 9216, v50
  v_add_u32 v4, v4, v51
  v_add_u32 v5, 294912, v4
  v_mov_b32 v63, 0x7ff00000
  v_cmp_gt_u32 vcc, 1, v49
  s_nop 1
  v_cndmask_b32 v5, v63, v5, vcc
  v_lshl_add_u32 v52, v47, 2, v46
  v_lshlrev_b32 v52, 1, v52
  v_lshlrev_b32 v53, 1, v50
  v_lshrrev_b32 v54, 3, v45
  v_and_b32 v55, 7, v45
  v_mul_u32_u24 v6, 1152, v54
  v_lshl_add_u32 v6, v55, 4, v6
  v_add_u32 v6, 1024, v6
  v_add_u32 v7, 1024, v1
  v_cmp_gt_u32 vcc, 8, v45
  s_nop 1
  v_cndmask_b32 v7, v63, v7, vcc
  v_lshlrev_b32 v60, 9, v44
  v_lshl_add_u32 v60, v47, 5, v60
  v_lshl_add_u32 v60, v46, 3, v60
  v_mov_b32 v63, 0xffff0000
  s_lshr_b32 s57, s2, 5
  s_and_b32 s58, s2, 31
  s_waitcnt lgkmcnt(0)
  s_lshl_b32 s60, s2, 20
  s_mov_b32 s36, s76
  s_mov_b32 s37, s77
  s_mov_b32 s38, 9216
  s_mov_b32 s39, 0x20000
  s_add_u32 s8, s78, s60
  s_addc_u32 s9, s79, 0
  s_mov_b32 s10, 1048576
  s_mov_b32 s11, 0x20000
  s_add_u32 s12, s80, s60
  s_addc_u32 s13, s81, 0
  s_mov_b32 s14, 1048576
  s_mov_b32 s15, 0x20000
  s_mov_b32 s16, s82
  s_mov_b32 s17, s83
  s_mov_b32 s18, 4718592
  s_mov_b32 s19, 0x20000
  s_mov_b32 s32, s84
  s_mov_b32 s33, s85
  s_mov_b32 s34, 4718592
  s_mov_b32 s35, 0x20000
  s_mov_b32 s20, s88
  s_mov_b32 s21, s89
  s_mov_b32 s22, 5308416
  s_mov_b32 s23, 0x20000
  s_mov_b32 s24, s90
  s_mov_b32 s25, s91
  s_mov_b32 s26, 5308416
  s_mov_b32 s27, 0x20000
  s_mov_b32 s28, s92
  s_mov_b32 s29, s93
  s_mov_b32 s30, 5308416
  s_mov_b32 s31, 0x20000
  s_mov_b32 s40, s94
  s_mov_b32 s41, s95
  s_mov_b32 s42, 1152
  s_mov_b32 s43, 0x20000
  s_mov_b32 s44, s96
  s_mov_b32 s45, s97
  s_mov_b32 s46, 9216
  s_mov_b32 s47, 0x20000
  s_mov_b32 s52, s98
  s_mov_b32 s53, s99
  s_mov_b32 s54, 256
  s_mov_b32 s55, 0x20000
  s_mov_b32 s48, s100
  s_mov_b32 s49, s101
  s_mov_b32 s50, 589824
  s_mov_b32 s51, 0x20000
  s_mov_b32 s84, 0xcccccccc
  s_mov_b32 s85, 0xcccccccc
  s_mov_b32 s86, 0xaaaaaaaa
  s_mov_b32 s87, 0xaaaaaaaa
  s_mul_i32 s59, s56, 4096
  s_mul_i32 s69, s56, 36
  s_mul_i32 s66, s57, 1152
  s_lshl_b32 s70, s69, 1
  s_add_u32 s70, s70, s66
  s_lshl_b32 s71, s58, 8
  s_mul_i32 s72, s56, 72
  s_lshl_b32 s61, s72, 13
  s_add_u32 s61, s61, s71
  s_lshl_b32 s74, s72, 1
  s_add_u32 s74, s74, s66
  s_mul_i32 s62, s69, 9216
  s_mov_b32 s63, s62
  s_add_u32 s62, s62, s71
  s_and_b32 s71, s58, 7
  s_lshl_b32 s71, s71, 6
  s_lshr_b32 s72, s58, 3
  s_lshl_b32 s72, s72, 4
  s_add_u32 s71, s71, s72
  s_add_u32 s71, s71, 4096
  s_lshl_b32 s72, s71, 1
  s_add_u32 s63, s63, s72
  s_add_u32 s71, s71, s56
  s_mul_i32 s65, s71, 1152
  s_lshl_b32 s71, s58, 7
  s_lshl_b32 s72, s56, 3
  s_add_u32 s71, s71, s72
  s_mul_i32 s64, s71, 1152
  s_add_u32 s71, s71, s72
  s_mul_i32 s73, s71, 1152
  s_cmp_ge_u32 s56, 8
  s_cselect_b32 s73, 0x7ff00000, s73
  buffer_load_ushort v9, v52, s[36:39], s70 offen
  buffer_load_ushort v10, v53, s[36:39], s70 offen
  buffer_load_ushort v11, v53, s[36:39], s70 offen offset:64
  s_cmp_ge_u32 s56, 8
  s_cbranch_scc1 L_young
  buffer_load_ushort v8, v52, s[36:39], s74 offen
  buffer_load_ushort v27, v52, s[36:39], s74 offen offset:128
  buffer_load_dwordx4 v[120:123], v2, s[16:19], s61 offen offset:0
  buffer_load_dwordx4 v[64:67], v1, s[8:11], s59 offen offset:0 nt
  s_add_u32 s60, s61, 32768
  buffer_load_dwordx4 v[124:127], v2, s[16:19], s60 offen offset:0
  buffer_load_dwordx4 v[68:71], v1, s[8:11], s59 offen offset:1024 nt
  s_add_u32 s60, s61, 65536
  buffer_load_dwordx4 v[96:99], v2, s[16:19], s60 offen offset:0
  buffer_load_dwordx4 v[72:75], v1, s[8:11], s59 offen offset:2048 nt
  s_add_u32 s60, s61, 98304
  buffer_load_dwordx4 v[100:103], v2, s[16:19], s60 offen offset:0
  buffer_load_dwordx4 v[76:79], v1, s[8:11], s59 offen offset:3072 nt
  s_add_u32 s60, s61, 131072
  buffer_load_dwordx4 v[104:107], v2, s[16:19], s60 offen offset:0
  s_add_u32 s60, s59, 65536
  buffer_load_dwordx4 v[80:83], v1, s[8:11], s60 offen offset:0 nt
  s_add_u32 s60, s61, 163840
  buffer_load_dwordx4 v[108:111], v2, s[16:19], s60 offen offset:0
  s_add_u32 s60, s59, 65536
  buffer_load_dwordx4 v[84:87], v1, s[8:11], s60 offen offset:1024 nt
  s_add_u32 s60, s61, 196608
  buffer_load_dwordx4 v[112:115], v2, s[16:19], s60 offen offset:0
  s_add_u32 s60, s59, 65536
  buffer_load_dwordx4 v[88:91], v1, s[8:11], s60 offen offset:2048 nt
  s_add_u32 s60, s61, 229376
  buffer_load_dwordx4 v[116:119], v2, s[16:19], s60 offen offset:0
  s_add_u32 s60, s59, 65536
  buffer_load_dwordx4 v[92:95], v1, s[8:11], s60 offen offset:3072 nt
  s_waitcnt vmcnt(15)
  v_lshlrev_b32 v8, 16, v8
  v_lshlrev_b32 v27, 16, v27
  v_lshlrev_b32 v44, 16, v120
  v_and_b32 v45, v63, v120
  v_lshlrev_b32 v46, 16, v121
  v_and_b32 v47, v63, v121
  v_lshlrev_b32 v48, 16, v122
  v_and_b32 v49, v63, v122
  v_lshlrev_b32 v50, 16, v123
  v_and_b32 v51, v63, v123
  v_mul_f32_dpp v28, v8, v44 row_newbcast:0 row_mask:0xf bank_mask:0xf
  v_mul_f32_dpp v29, v8, v45 row_newbcast:0 row_mask:0xf bank_mask:0xf
  v_mul_f32_dpp v30, v8, v46 row_newbcast:0 row_mask:0xf bank_mask:0xf
  v_mul_f32_dpp v31, v8, v47 row_newbcast:0 row_mask:0xf bank_mask:0xf
  v_mul_f32_dpp v32, v8, v48 row_newbcast:0 row_mask:0xf bank_mask:0xf
  v_mul_f32_dpp v33, v8, v49 row_newbcast:0 row_mask:0xf bank_mask:0xf
  v_mul_f32_dpp v34, v8, v50 row_newbcast:0 row_mask:0xf bank_mask:0xf
  v_mul_f32_dpp v35, v8, v51 row_newbcast:0 row_mask:0xf bank_mask:0xf
  s_add_u32 s60, s61, 262144
  buffer_load_dwordx4 v[120:123], v2, s[16:19], s60 offen offset:0
  s_waitcnt vmcnt(14)
  v_lshlrev_b32 v44, 16, v124
  v_and_b32 v45, v63, v124
  v_lshlrev_b32 v46, 16, v125
  v_and_b32 v47, v63, v125
  v_lshlrev_b32 v48, 16, v126
  v_and_b32 v49, v63, v126
  v_lshlrev_b32 v50, 16, v127
  v_and_b32 v51, v63, v127
  v_fmac_f32_dpp v28, v8, v44 row_newbcast:1 row_mask:0xf bank_mask:0xf
  v_fmac_f32_dpp v29, v8, v45 row_newbcast:1 row_mask:0xf bank_mask:0xf
  v_fmac_f32_dpp v30, v8, v46 row_newbcast:1 row_mask:0xf bank_mask:0xf
  v_fmac_f32_dpp v31, v8, v47 row_newbcast:1 row_mask:0xf bank_mask:0xf
  v_fmac_f32_dpp v32, v8, v48 row_newbcast:1 row_mask:0xf bank_mask:0xf
  v_fmac_f32_dpp v33, v8, v49 row_newbcast:1 row_mask:0xf bank_mask:0xf
  v_fmac_f32_dpp v34, v8, v50 row_newbcast:1 row_mask:0xf bank_mask:0xf
  v_fmac_f32_dpp v35, v8, v51 row_newbcast:1 row_mask:0xf bank_mask:0xf
  s_add_u32 s60, s61, 294912
  buffer_load_dwordx4 v[124:127], v2, s[16:19], s60 offen offset:0
  s_waitcnt vmcnt(13)
  v_lshlrev_b32 v44, 16, v96
  v_and_b32 v45, v63, v96
  v_lshlrev_b32 v46, 16, v97
  v_and_b32 v47, v63, v97
  v_lshlrev_b32 v48, 16, v98
  v_and_b32 v49, v63, v98
  v_lshlrev_b32 v50, 16, v99
  v_and_b32 v51, v63, v99
  v_fmac_f32_dpp v28, v8, v44 row_newbcast:2 row_mask:0xf bank_mask:0xf
  v_fmac_f32_dpp v29, v8, v45 row_newbcast:2 row_mask:0xf bank_mask:0xf
  v_fmac_f32_dpp v30, v8, v46 row_newbcast:2 row_mask:0xf bank_mask:0xf
  v_fmac_f32_dpp v31, v8, v47 row_newbcast:2 row_mask:0xf bank_mask:0xf
  v_fmac_f32_dpp v32, v8, v48 row_newbcast:2 row_mask:0xf bank_mask:0xf
  v_fmac_f32_dpp v33, v8, v49 row_newbcast:2 row_mask:0xf bank_mask:0xf
  v_fmac_f32_dpp v34, v8, v50 row_newbcast:2 row_mask:0xf bank_mask:0xf
  v_fmac_f32_dpp v35, v8, v51 row_newbcast:2 row_mask:0xf bank_mask:0xf
  s_add_u32 s60, s61, 327680
  buffer_load_dwordx4 v[96:99], v2, s[16:19], s60 offen offset:0
  s_waitcnt vmcnt(12)
  v_lshlrev_b32 v44, 16, v100
  v_and_b32 v45, v63, v100
  v_lshlrev_b32 v46, 16, v101
  v_and_b32 v47, v63, v101
  v_lshlrev_b32 v48, 16, v102
  v_and_b32 v49, v63, v102
  v_lshlrev_b32 v50, 16, v103
  v_and_b32 v51, v63, v103
  v_fmac_f32_dpp v28, v8, v44 row_newbcast:3 row_mask:0xf bank_mask:0xf
  v_fmac_f32_dpp v29, v8, v45 row_newbcast:3 row_mask:0xf bank_mask:0xf
  v_fmac_f32_dpp v30, v8, v46 row_newbcast:3 row_mask:0xf bank_mask:0xf
  v_fmac_f32_dpp v31, v8, v47 row_newbcast:3 row_mask:0xf bank_mask:0xf
  v_fmac_f32_dpp v32, v8, v48 row_newbcast:3 row_mask:0xf bank_mask:0xf
  v_fmac_f32_dpp v33, v8, v49 row_newbcast:3 row_mask:0xf bank_mask:0xf
  v_fmac_f32_dpp v34, v8, v50 row_newbcast:3 row_mask:0xf bank_mask:0xf
  v_fmac_f32_dpp v35, v8, v51 row_newbcast:3 row_mask:0xf bank_mask:0xf
  s_add_u32 s60, s61, 360448
  buffer_load_dwordx4 v[100:103], v2, s[16:19], s60 offen offset:0
  s_waitcnt vmcnt(11)
  v_lshlrev_b32 v44, 16, v104
  v_and_b32 v45, v63, v104
  v_lshlrev_b32 v46, 16, v105
  v_and_b32 v47, v63, v105
  v_lshlrev_b32 v48, 16, v106
  v_and_b32 v49, v63, v106
  v_lshlrev_b32 v50, 16, v107
  v_and_b32 v51, v63, v107
  v_fmac_f32_dpp v28, v8, v44 row_newbcast:4 row_mask:0xf bank_mask:0xf
  v_fmac_f32_dpp v29, v8, v45 row_newbcast:4 row_mask:0xf bank_mask:0xf
  v_fmac_f32_dpp v30, v8, v46 row_newbcast:4 row_mask:0xf bank_mask:0xf
  v_fmac_f32_dpp v31, v8, v47 row_newbcast:4 row_mask:0xf bank_mask:0xf
  v_fmac_f32_dpp v32, v8, v48 row_newbcast:4 row_mask:0xf bank_mask:0xf
  v_fmac_f32_dpp v33, v8, v49 row_newbcast:4 row_mask:0xf bank_mask:0xf
  v_fmac_f32_dpp v34, v8, v50 row_newbcast:4 row_mask:0xf bank_mask:0xf
  v_fmac_f32_dpp v35, v8, v51 row_newbcast:4 row_mask:0xf bank_mask:0xf
  s_add_u32 s60, s61, 393216
  buffer_load_dwordx4 v[104:107], v2, s[16:19], s60 offen offset:0
  s_waitcnt vmcnt(10)
  v_lshlrev_b32 v44, 16, v108
  v_and_b32 v45, v63, v108
  v_lshlrev_b32 v46, 16, v109
  v_and_b32 v47, v63, v109
  v_lshlrev_b32 v48, 16, v110
  v_and_b32 v49, v63, v110
  v_lshlrev_b32 v50, 16, v111
  v_and_b32 v51, v63, v111
  v_fmac_f32_dpp v28, v8, v44 row_newbcast:5 row_mask:0xf bank_mask:0xf
  v_fmac_f32_dpp v29, v8, v45 row_newbcast:5 row_mask:0xf bank_mask:0xf
  v_fmac_f32_dpp v30, v8, v46 row_newbcast:5 row_mask:0xf bank_mask:0xf
  v_fmac_f32_dpp v31, v8, v47 row_newbcast:5 row_mask:0xf bank_mask:0xf
  v_fmac_f32_dpp v32, v8, v48 row_newbcast:5 row_mask:0xf bank_mask:0xf
  v_fmac_f32_dpp v33, v8, v49 row_newbcast:5 row_mask:0xf bank_mask:0xf
  v_fmac_f32_dpp v34, v8, v50 row_newbcast:5 row_mask:0xf bank_mask:0xf
  v_fmac_f32_dpp v35, v8, v51 row_newbcast:5 row_mask:0xf bank_mask:0xf
  s_add_u32 s60, s61, 425984
  buffer_load_dwordx4 v[108:111], v2, s[16:19], s60 offen offset:0
  s_waitcnt vmcnt(9)
  v_lshlrev_b32 v44, 16, v112
  v_and_b32 v45, v63, v112
  v_lshlrev_b32 v46, 16, v113
  v_and_b32 v47, v63, v113
  v_lshlrev_b32 v48, 16, v114
  v_and_b32 v49, v63, v114
  v_lshlrev_b32 v50, 16, v115
  v_and_b32 v51, v63, v115
  v_fmac_f32_dpp v28, v8, v44 row_newbcast:6 row_mask:0xf bank_mask:0xf
  v_fmac_f32_dpp v29, v8, v45 row_newbcast:6 row_mask:0xf bank_mask:0xf
  v_fmac_f32_dpp v30, v8, v46 row_newbcast:6 row_mask:0xf bank_mask:0xf
  v_fmac_f32_dpp v31, v8, v47 row_newbcast:6 row_mask:0xf bank_mask:0xf
  v_fmac_f32_dpp v32, v8, v48 row_newbcast:6 row_mask:0xf bank_mask:0xf
  v_fmac_f32_dpp v33, v8, v49 row_newbcast:6 row_mask:0xf bank_mask:0xf
  v_fmac_f32_dpp v34, v8, v50 row_newbcast:6 row_mask:0xf bank_mask:0xf
  v_fmac_f32_dpp v35, v8, v51 row_newbcast:6 row_mask:0xf bank_mask:0xf
  s_add_u32 s60, s61, 458752
  buffer_load_dwordx4 v[112:115], v2, s[16:19], s60 offen offset:0
  s_waitcnt vmcnt(8)
  v_lshlrev_b32 v44, 16, v116
  v_and_b32 v45, v63, v116
  v_lshlrev_b32 v46, 16, v117
  v_and_b32 v47, v63, v117
  v_lshlrev_b32 v48, 16, v118
  v_and_b32 v49, v63, v118
  v_lshlrev_b32 v50, 16, v119
  v_and_b32 v51, v63, v119
  v_fmac_f32_dpp v28, v8, v44 row_newbcast:7 row_mask:0xf bank_mask:0xf
  v_fmac_f32_dpp v29, v8, v45 row_newbcast:7 row_mask:0xf bank_mask:0xf
  v_fmac_f32_dpp v30, v8, v46 row_newbcast:7 row_mask:0xf bank_mask:0xf
  v_fmac_f32_dpp v31, v8, v47 row_newbcast:7 row_mask:0xf bank_mask:0xf
  v_fmac_f32_dpp v32, v8, v48 row_newbcast:7 row_mask:0xf bank_mask:0xf
  v_fmac_f32_dpp v33, v8, v49 row_newbcast:7 row_mask:0xf bank_mask:0xf
  v_fmac_f32_dpp v34, v8, v50 row_newbcast:7 row_mask:0xf bank_mask:0xf
  v_fmac_f32_dpp v35, v8, v51 row_newbcast:7 row_mask:0xf bank_mask:0xf
  s_add_u32 s60, s61, 491520
  buffer_load_dwordx4 v[116:119], v2, s[16:19], s60 offen offset:0
  s_waitcnt vmcnt(7)
  v_lshlrev_b32 v44, 16, v120
  v_and_b32 v45, v63, v120
  v_lshlrev_b32 v46, 16, v121
  v_and_b32 v47, v63, v121
  v_lshlrev_b32 v48, 16, v122
  v_and_b32 v49, v63, v122
  v_lshlrev_b32 v50, 16, v123
  v_and_b32 v51, v63, v123
  v_fmac_f32_dpp v28, v8, v44 row_newbcast:8 row_mask:0xf bank_mask:0xf
  v_fmac_f32_dpp v29, v8, v45 row_newbcast:8 row_mask:0xf bank_mask:0xf
  v_fmac_f32_dpp v30, v8, v46 row_newbcast:8 row_mask:0xf bank_mask:0xf
  v_fmac_f32_dpp v31, v8, v47 row_newbcast:8 row_mask:0xf bank_mask:0xf
  v_fmac_f32_dpp v32, v8, v48 row_newbcast:8 row_mask:0xf bank_mask:0xf
  v_fmac_f32_dpp v33, v8, v49 row_newbcast:8 row_mask:0xf bank_mask:0xf
  v_fmac_f32_dpp v34, v8, v50 row_newbcast:8 row_mask:0xf bank_mask:0xf
  v_fmac_f32_dpp v35, v8, v51 row_newbcast:8 row_mask:0xf bank_mask:0xf
  s_add_u32 s60, s61, 524288
  buffer_load_dwordx4 v[120:123], v2, s[16:19], s60 offen offset:0
  s_waitcnt vmcnt(7)
  v_lshlrev_b32 v44, 16, v124
  v_and_b32 v45, v63, v124
  v_lshlrev_b32 v46, 16, v125
  v_and_b32 v47, v63, v125
  v_lshlrev_b32 v48, 16, v126
  v_and_b32 v49, v63, v126
  v_lshlrev_b32 v50, 16, v127
  v_and_b32 v51, v63, v127
  v_fmac_f32_dpp v28, v8, v44 row_newbcast:9 row_mask:0xf bank_mask:0xf
  v_fmac_f32_dpp v29, v8, v45 row_newbcast:9 row_mask:0xf bank_mask:0xf
  v_fmac_f32_dpp v30, v8, v46 row_newbcast:9 row_mask:0xf bank_mask:0xf
  v_fmac_f32_dpp v31, v8, v47 row_newbcast:9 row_mask:0xf bank_mask:0xf
  v_fmac_f32_dpp v32, v8, v48 row_newbcast:9 row_mask:0xf bank_mask:0xf
  v_fmac_f32_dpp v33, v8, v49 row_newbcast:9 row_mask:0xf bank_mask:0xf
  v_fmac_f32_dpp v34, v8, v50 row_newbcast:9 row_mask:0xf bank_mask:0xf
  v_fmac_f32_dpp v35, v8, v51 row_newbcast:9 row_mask:0xf bank_mask:0xf
  s_add_u32 s60, s61, 557056
  buffer_load_dwordx4 v[124:127], v2, s[16:19], s60 offen offset:0
  s_waitcnt vmcnt(7)
  v_lshlrev_b32 v44, 16, v96
  v_and_b32 v45, v63, v96
  v_lshlrev_b32 v46, 16, v97
  v_and_b32 v47, v63, v97
  v_lshlrev_b32 v48, 16, v98
  v_and_b32 v49, v63, v98
  v_lshlrev_b32 v50, 16, v99
  v_and_b32 v51, v63, v99
  v_fmac_f32_dpp v28, v8, v44 row_newbcast:10 row_mask:0xf bank_mask:0xf
  v_fmac_f32_dpp v29, v8, v45 row_newbcast:10 row_mask:0xf bank_mask:0xf
  v_fmac_f32_dpp v30, v8, v46 row_newbcast:10 row_mask:0xf bank_mask:0xf
  v_fmac_f32_dpp v31, v8, v47 row_newbcast:10 row_mask:0xf bank_mask:0xf
  v_fmac_f32_dpp v32, v8, v48 row_newbcast:10 row_mask:0xf bank_mask:0xf
  v_fmac_f32_dpp v33, v8, v49 row_newbcast:10 row_mask:0xf bank_mask:0xf
  v_fmac_f32_dpp v34, v8, v50 row_newbcast:10 row_mask:0xf bank_mask:0xf
  v_fmac_f32_dpp v35, v8, v51 row_newbcast:10 row_mask:0xf bank_mask:0xf
  buffer_load_dwordx4 v[96:99], v3, s[20:23], s62 offen offset:0
  s_waitcnt vmcnt(7)
  v_lshlrev_b32 v44, 16, v100
  v_and_b32 v45, v63, v100
  v_lshlrev_b32 v46, 16, v101
  v_and_b32 v47, v63, v101
  v_lshlrev_b32 v48, 16, v102
  v_and_b32 v49, v63, v102
  v_lshlrev_b32 v50, 16, v103
  v_and_b32 v51, v63, v103
  v_fmac_f32_dpp v28, v8, v44 row_newbcast:11 row_mask:0xf bank_mask:0xf
  v_fmac_f32_dpp v29, v8, v45 row_newbcast:11 row_mask:0xf bank_mask:0xf
  v_fmac_f32_dpp v30, v8, v46 row_newbcast:11 row_mask:0xf bank_mask:0xf
  v_fmac_f32_dpp v31, v8, v47 row_newbcast:11 row_mask:0xf bank_mask:0xf
  v_fmac_f32_dpp v32, v8, v48 row_newbcast:11 row_mask:0xf bank_mask:0xf
  v_fmac_f32_dpp v33, v8, v49 row_newbcast:11 row_mask:0xf bank_mask:0xf
  v_fmac_f32_dpp v34, v8, v50 row_newbcast:11 row_mask:0xf bank_mask:0xf
  v_fmac_f32_dpp v35, v8, v51 row_newbcast:11 row_mask:0xf bank_mask:0xf
  s_add_u32 s60, s59, 131072
  buffer_load_dwordx4 v[100:103], v1, s[8:11], s60 offen offset:0 nt
  s_waitcnt vmcnt(7)
  v_lshlrev_b32 v44, 16, v104
  v_and_b32 v45, v63, v104
  v_lshlrev_b32 v46, 16, v105
  v_and_b32 v47, v63, v105
  v_lshlrev_b32 v48, 16, v106
  v_and_b32 v49, v63, v106
  v_lshlrev_b32 v50, 16, v107
  v_and_b32 v51, v63, v107
  v_fmac_f32_dpp v28, v8, v44 row_newbcast:12 row_mask:0xf bank_mask:0xf
  v_fmac_f32_dpp v29, v8, v45 row_newbcast:12 row_mask:0xf bank_mask:0xf
  v_fmac_f32_dpp v30, v8, v46 row_newbcast:12 row_mask:0xf bank_mask:0xf
  v_fmac_f32_dpp v31, v8, v47 row_newbcast:12 row_mask:0xf bank_mask:0xf
  v_fmac_f32_dpp v32, v8, v48 row_newbcast:12 row_mask:0xf bank_mask:0xf
  v_fmac_f32_dpp v33, v8, v49 row_newbcast:12 row_mask:0xf bank_mask:0xf
  v_fmac_f32_dpp v34, v8, v50 row_newbcast:12 row_mask:0xf bank_mask:0xf
  v_fmac_f32_dpp v35, v8, v51 row_newbcast:12 row_mask:0xf bank_mask:0xf
  s_add_u32 s60, s59, 131072
  buffer_load_dwordx4 v[104:107], v1, s[8:11], s60 offen offset:1024 nt
  s_waitcnt vmcnt(7)
  v_lshlrev_b32 v44, 16, v108
  v_and_b32 v45, v63, v108
  v_lshlrev_b32 v46, 16, v109
  v_and_b32 v47, v63, v109
  v_lshlrev_b32 v48, 16, v110
  v_and_b32 v49, v63, v110
  v_lshlrev_b32 v50, 16, v111
  v_and_b32 v51, v63, v111
  v_fmac_f32_dpp v28, v8, v44 row_newbcast:13 row_mask:0xf bank_mask:0xf
  v_fmac_f32_dpp v29, v8, v45 row_newbcast:13 row_mask:0xf bank_mask:0xf
  v_fmac_f32_dpp v30, v8, v46 row_newbcast:13 row_mask:0xf bank_mask:0xf
  v_fmac_f32_dpp v31, v8, v47 row_newbcast:13 row_mask:0xf bank_mask:0xf
  v_fmac_f32_dpp v32, v8, v48 row_newbcast:13 row_mask:0xf bank_mask:0xf
  v_fmac_f32_dpp v33, v8, v49 row_newbcast:13 row_mask:0xf bank_mask:0xf
  v_fmac_f32_dpp v34, v8, v50 row_newbcast:13 row_mask:0xf bank_mask:0xf
  v_fmac_f32_dpp v35, v8, v51 row_newbcast:13 row_mask:0xf bank_mask:0xf
  s_add_u32 s60, s62, 36864
  buffer_load_dwordx4 v[108:111], v3, s[20:23], s60 offen offset:0
  s_waitcnt vmcnt(7)
  v_lshlrev_b32 v44, 16, v112
  v_and_b32 v45, v63, v112
  v_lshlrev_b32 v46, 16, v113
  v_and_b32 v47, v63, v113
  v_lshlrev_b32 v48, 16, v114
  v_and_b32 v49, v63, v114
  v_lshlrev_b32 v50, 16, v115
  v_and_b32 v51, v63, v115
  v_fmac_f32_dpp v28, v8, v44 row_newbcast:14 row_mask:0xf bank_mask:0xf
  v_fmac_f32_dpp v29, v8, v45 row_newbcast:14 row_mask:0xf bank_mask:0xf
  v_fmac_f32_dpp v30, v8, v46 row_newbcast:14 row_mask:0xf bank_mask:0xf
  v_fmac_f32_dpp v31, v8, v47 row_newbcast:14 row_mask:0xf bank_mask:0xf
  v_fmac_f32_dpp v32, v8, v48 row_newbcast:14 row_mask:0xf bank_mask:0xf
  v_fmac_f32_dpp v33, v8, v49 row_newbcast:14 row_mask:0xf bank_mask:0xf
  v_fmac_f32_dpp v34, v8, v50 row_newbcast:14 row_mask:0xf bank_mask:0xf
  v_fmac_f32_dpp v35, v8, v51 row_newbcast:14 row_mask:0xf bank_mask:0xf
  s_add_u32 s60, s59, 131072
  buffer_load_dwordx4 v[112:115], v1, s[8:11], s60 offen offset:2048 nt
  s_waitcnt vmcnt(7)
  v_lshlrev_b32 v44, 16, v116
  v_and_b32 v45, v63, v116
  v_lshlrev_b32 v46, 16, v117
  v_and_b32 v47, v63, v117
  v_lshlrev_b32 v48, 16, v118
  v_and_b32 v49, v63, v118
  v_lshlrev_b32 v50, 16, v119
  v_and_b32 v51, v63, v119
  v_fmac_f32_dpp v28, v8, v44 row_newbcast:15 row_mask:0xf bank_mask:0xf
  v_fmac_f32_dpp v29, v8, v45 row_newbcast:15 row_mask:0xf bank_mask:0xf
  v_fmac_f32_dpp v30, v8, v46 row_newbcast:15 row_mask:0xf bank_mask:0xf
  v_fmac_f32_dpp v31, v8, v47 row_newbcast:15 row_mask:0xf bank_mask:0xf
  v_fmac_f32_dpp v32, v8, v48 row_newbcast:15 row_mask:0xf bank_mask:0xf
  v_fmac_f32_dpp v33, v8, v49 row_newbcast:15 row_mask:0xf bank_mask:0xf
  v_fmac_f32_dpp v34, v8, v50 row_newbcast:15 row_mask:0xf bank_mask:0xf
  v_fmac_f32_dpp v35, v8, v51 row_newbcast:15 row_mask:0xf bank_mask:0xf
  s_add_u32 s60, s59, 131072
  buffer_load_dwordx4 v[116:119], v1, s[8:11], s60 offen offset:3072 nt
  s_waitcnt vmcnt(7)
  v_lshlrev_b32 v44, 16, v120
  v_and_b32 v45, v63, v120
  v_lshlrev_b32 v46, 16, v121
  v_and_b32 v47, v63, v121
  v_lshlrev_b32 v48, 16, v122
  v_and_b32 v49, v63, v122
  v_lshlrev_b32 v50, 16, v123
  v_and_b32 v51, v63, v123
  v_fmac_f32_dpp v28, v27, v44 row_newbcast:0 row_mask:0xf bank_mask:0xf
  v_fmac_f32_dpp v29, v27, v45 row_newbcast:0 row_mask:0xf bank_mask:0xf
  v_fmac_f32_dpp v30, v27, v46 row_newbcast:0 row_mask:0xf bank_mask:0xf
  v_fmac_f32_dpp v31, v27, v47 row_newbcast:0 row_mask:0xf bank_mask:0xf
  v_fmac_f32_dpp v32, v27, v48 row_newbcast:0 row_mask:0xf bank_mask:0xf
  v_fmac_f32_dpp v33, v27, v49 row_newbcast:0 row_mask:0xf bank_mask:0xf
  v_fmac_f32_dpp v34, v27, v50 row_newbcast:0 row_mask:0xf bank_mask:0xf
  v_fmac_f32_dpp v35, v27, v51 row_newbcast:0 row_mask:0xf bank_mask:0xf
  s_add_u32 s60, s62, 73728
  buffer_load_dwordx4 v[120:123], v3, s[20:23], s60 offen offset:0
  s_waitcnt vmcnt(7)
  v_lshlrev_b32 v44, 16, v124
  v_and_b32 v45, v63, v124
  v_lshlrev_b32 v46, 16, v125
  v_and_b32 v47, v63, v125
  v_lshlrev_b32 v48, 16, v126
  v_and_b32 v49, v63, v126
  v_lshlrev_b32 v50, 16, v127
  v_and_b32 v51, v63, v127
  v_fmac_f32_dpp v28, v27, v44 row_newbcast:1 row_mask:0xf bank_mask:0xf
  v_fmac_f32_dpp v29, v27, v45 row_newbcast:1 row_mask:0xf bank_mask:0xf
  v_fmac_f32_dpp v30, v27, v46 row_newbcast:1 row_mask:0xf bank_mask:0xf
  v_fmac_f32_dpp v31, v27, v47 row_newbcast:1 row_mask:0xf bank_mask:0xf
  v_fmac_f32_dpp v32, v27, v48 row_newbcast:1 row_mask:0xf bank_mask:0xf
  v_fmac_f32_dpp v33, v27, v49 row_newbcast:1 row_mask:0xf bank_mask:0xf
  v_fmac_f32_dpp v34, v27, v50 row_newbcast:1 row_mask:0xf bank_mask:0xf
  v_fmac_f32_dpp v35, v27, v51 row_newbcast:1 row_mask:0xf bank_mask:0xf
  s_add_u32 s60, s59, 196608
  buffer_load_dwordx4 v[124:127], v1, s[8:11], s60 offen offset:0 nt
  v_permlane32_swap_b32 v28, v32
  v_permlane32_swap_b32 v29, v33
  v_permlane32_swap_b32 v30, v34
  v_permlane32_swap_b32 v31, v35
  v_add_f32 v28, v28, v32
  v_add_f32 v29, v29, v33
  v_add_f32 v30, v30, v34
  v_add_f32 v31, v31, v35
  s_nop 0
  v_permlane16_swap_b32 v28, v30
  v_permlane16_swap_b32 v29, v31
  v_add_f32 v28, v28, v30
  v_add_f32 v29, v29, v31
  ds_write_b64 v60, v[28:29] offset:0
  s_branch L_qjoin
L_young:
  buffer_load_dwordx4 v[64:67], v1, s[8:11], s59 offen offset:0 nt
  buffer_load_dwordx4 v[68:71], v1, s[8:11], s59 offen offset:1024 nt
  buffer_load_dwordx4 v[72:75], v1, s[8:11], s59 offen offset:2048 nt
  buffer_load_dwordx4 v[76:79], v1, s[8:11], s59 offen offset:3072 nt
  s_add_u32 s60, s59, 65536
  buffer_load_dwordx4 v[80:83], v1, s[8:11], s60 offen offset:0 nt
  s_add_u32 s60, s59, 65536
  buffer_load_dwordx4 v[84:87], v1, s[8:11], s60 offen offset:1024 nt
  s_add_u32 s60, s59, 65536
  buffer_load_dwordx4 v[88:91], v1, s[8:11], s60 offen offset:2048 nt
  s_add_u32 s60, s59, 65536
  buffer_load_dwordx4 v[92:95], v1, s[8:11], s60 offen offset:3072 nt
  buffer_load_dwordx4 v[96:99], v3, s[20:23], s62 offen offset:0
  s_add_u32 s60, s59, 131072
  buffer_load_dwordx4 v[100:103], v1, s[8:11], s60 offen offset:0 nt
  s_add_u32 s60, s59, 131072
  buffer_load_dwordx4 v[104:107], v1, s[8:11], s60 offen offset:1024 nt
  s_add_u32 s60, s62, 36864
  buffer_load_dwordx4 v[108:111], v3, s[20:23], s60 offen offset:0
  s_add_u32 s60, s59, 131072
  buffer_load_dwordx4 v[112:115], v1, s[8:11], s60 offen offset:2048 nt
  s_add_u32 s60, s59, 131072
  buffer_load_dwordx4 v[116:119], v1, s[8:11], s60 offen offset:3072 nt
  s_add_u32 s60, s62, 73728
  buffer_load_dwordx4 v[120:123], v3, s[20:23], s60 offen offset:0
  s_add_u32 s60, s59, 196608
  buffer_load_dwordx4 v[124:127], v1, s[8:11], s60 offen offset:0 nt
L_qjoin:
  s_waitcnt lgkmcnt(0)
  s_barrier
  v_lshrrev_b32 v44, 1, v1
  ds_read_b64 v[28:29], v44 offset:0
  ds_read_b64 v[30:31], v44 offset:512
  ds_read_b64 v[32:33], v44 offset:1024
  ds_read_b64 v[34:35], v44 offset:1536
  s_waitcnt lgkmcnt(0)
  v_mov_b32 v46, v28
  v_mov_b32 v47, v29
  v_add_f32 v46, v46, v30
  v_add_f32 v47, v47, v31
  v_add_f32 v46, v46, v32
  v_add_f32 v47, v47, v33
  v_add_f32 v46, v46, v34
  v_add_f32 v47, v47, v35
  ds_read_b64 v[28:29], v44 offset:2048
  ds_read_b64 v[30:31], v44 offset:2560
  ds_read_b64 v[32:33], v44 offset:3072
  ds_read_b64 v[34:35], v44 offset:3584
  s_waitcnt lgkmcnt(0)
  v_add_f32 v46, v46, v28
  v_add_f32 v47, v47, v29
  v_add_f32 v46, v46, v30
  v_add_f32 v47, v47, v31
  v_add_f32 v46, v46, v32
  v_add_f32 v47, v47, v33
  v_add_f32 v46, v46, v34
  v_add_f32 v47, v47, v35
  v_cvt_pk_bf16_f32 v46, v46, v47
  v_and_b32 v48, 0xf0, v1
  ds_bpermute_b32 v12, v48, v46
  v_add_u32 v48, 4, v48
  ds_bpermute_b32 v13, v48, v46
  v_add_u32 v48, 4, v48
  ds_bpermute_b32 v14, v48, v46
  v_add_u32 v48, 4, v48
  ds_bpermute_b32 v15, v48, v46
  s_waitcnt lgkmcnt(0)
  s_waitcnt vmcnt(15)
  v_dot2_f32_bf16 v52, v64, v12, 0
  v_dot2_f32_bf16 v52, v65, v13, v52
  v_dot2_f32_bf16 v52, v66, v14, v52
  v_dot2_f32_bf16 v52, v67, v15, v52
  s_add_u32 s60, s59, 196608
  buffer_load_dwordx4 v[64:67], v1, s[8:11], s60 offen offset:1024 nt
  s_waitcnt vmcnt(15)
  v_dot2_f32_bf16 v53, v68, v12, 0
  v_dot2_f32_bf16 v53, v69, v13, v53
  v_dot2_f32_bf16 v53, v70, v14, v53
  v_dot2_f32_bf16 v53, v71, v15, v53
  v_add_f32_dpp v54, v52, v52 row_ror:8 row_mask:0xf bank_mask:0x3
  s_nop 1
  v_add_f32_dpp v54, v53, v53 row_ror:8 row_mask:0xf bank_mask:0xc
  s_add_u32 s60, s62, 110592
  buffer_load_dwordx4 v[68:71], v3, s[20:23], s60 offen offset:0
  s_waitcnt vmcnt(15)
  v_dot2_f32_bf16 v52, v72, v12, 0
  v_dot2_f32_bf16 v52, v73, v13, v52
  v_dot2_f32_bf16 v52, v74, v14, v52
  v_dot2_f32_bf16 v52, v75, v15, v52
  s_add_u32 s60, s59, 196608
  buffer_load_dwordx4 v[72:75], v1, s[8:11], s60 offen offset:2048 nt
  s_waitcnt vmcnt(15)
  v_dot2_f32_bf16 v53, v76, v12, 0
  v_dot2_f32_bf16 v53, v77, v13, v53
  v_dot2_f32_bf16 v53, v78, v14, v53
  v_dot2_f32_bf16 v53, v79, v15, v53
  v_add_f32_dpp v55, v52, v52 row_ror:8 row_mask:0xf bank_mask:0x3
  s_nop 1
  v_add_f32_dpp v55, v53, v53 row_ror:8 row_mask:0xf bank_mask:0xc
  v_add_f32_dpp v56, v54, v54 row_shl:4 row_mask:0xf bank_mask:0x5
  s_nop 1
  v_add_f32_dpp v56, v55, v55 row_shr:4 row_mask:0xf bank_mask:0xa
  s_add_u32 s60, s59, 196608
  buffer_load_dwordx4 v[76:79], v1, s[8:11], s60 offen offset:3072 nt
  s_waitcnt vmcnt(15)
  v_dot2_f32_bf16 v52, v80, v12, 0
  v_dot2_f32_bf16 v52, v81, v13, v52
  v_dot2_f32_bf16 v52, v82, v14, v52
  v_dot2_f32_bf16 v52, v83, v15, v52
  buffer_load_dwordx4 v[80:83], v1, s[12:15], s59 offen offset:0 nt
  s_waitcnt vmcnt(15)
  v_dot2_f32_bf16 v53, v84, v12, 0
  v_dot2_f32_bf16 v53, v85, v13, v53
  v_dot2_f32_bf16 v53, v86, v14, v53
  v_dot2_f32_bf16 v53, v87, v15, v53
  v_add_f32_dpp v54, v52, v52 row_ror:8 row_mask:0xf bank_mask:0x3
  s_nop 1
  v_add_f32_dpp v54, v53, v53 row_ror:8 row_mask:0xf bank_mask:0xc
  s_add_u32 s60, s62, 147456
  buffer_load_dwordx4 v[84:87], v3, s[20:23], s60 offen offset:0
  s_waitcnt vmcnt(15)
  v_dot2_f32_bf16 v52, v88, v12, 0
  v_dot2_f32_bf16 v52, v89, v13, v52
  v_dot2_f32_bf16 v52, v90, v14, v52
  v_dot2_f32_bf16 v52, v91, v15, v52
  buffer_load_dwordx4 v[88:91], v1, s[12:15], s59 offen offset:1024 nt
  s_waitcnt vmcnt(15)
  v_dot2_f32_bf16 v53, v92, v12, 0
  v_dot2_f32_bf16 v53, v93, v13, v53
  v_dot2_f32_bf16 v53, v94, v14, v53
  v_dot2_f32_bf16 v53, v95, v15, v53
  v_add_f32_dpp v55, v52, v52 row_ror:8 row_mask:0xf bank_mask:0x3
  s_nop 1
  v_add_f32_dpp v55, v53, v53 row_ror:8 row_mask:0xf bank_mask:0xc
  v_add_f32_dpp v57, v54, v54 row_shl:4 row_mask:0xf bank_mask:0x5
  s_nop 1
  v_add_f32_dpp v57, v55, v55 row_shr:4 row_mask:0xf bank_mask:0xa
  v_add_f32_dpp v56, v56, v56 quad_perm:[2,3,0,1] row_mask:0xf bank_mask:0xf
  s_nop 0
  v_add_f32_dpp v57, v57, v57 quad_perm:[2,3,0,1] row_mask:0xf bank_mask:0xf
  v_cndmask_b32 v58, v56, v57, s[84:85]
  buffer_load_dwordx4 v[92:95], v1, s[12:15], s59 offen offset:2048 nt
  s_waitcnt vmcnt(15)
  v_lshlrev_b32 v9, 16, v9
  v_lshlrev_b32 v10, 16, v10
  v_lshlrev_b32 v11, 16, v11
  v_lshlrev_b32 v44, 16, v96
  v_and_b32 v45, v63, v96
  v_lshlrev_b32 v46, 16, v97
  v_and_b32 v47, v63, v97
  v_lshlrev_b32 v48, 16, v98
  v_and_b32 v49, v63, v98
  v_lshlrev_b32 v50, 16, v99
  v_and_b32 v51, v63, v99
  v_mul_f32_dpp v28, v9, v44 row_newbcast:0 row_mask:0xf bank_mask:0xf
  v_mul_f32_dpp v29, v9, v45 row_newbcast:0 row_mask:0xf bank_mask:0xf
  v_mul_f32_dpp v30, v9, v46 row_newbcast:0 row_mask:0xf bank_mask:0xf
  v_mul_f32_dpp v31, v9, v47 row_newbcast:0 row_mask:0xf bank_mask:0xf
  v_mul_f32_dpp v32, v9, v48 row_newbcast:0 row_mask:0xf bank_mask:0xf
  v_mul_f32_dpp v33, v9, v49 row_newbcast:0 row_mask:0xf bank_mask:0xf
  v_mul_f32_dpp v34, v9, v50 row_newbcast:0 row_mask:0xf bank_mask:0xf
  v_mul_f32_dpp v35, v9, v51 row_newbcast:0 row_mask:0xf bank_mask:0xf
  s_add_u32 s60, s62, 184320
  buffer_load_dwordx4 v[96:99], v3, s[20:23], s60 offen offset:0
  s_waitcnt vmcnt(15)
  v_dot2_f32_bf16 v52, v100, v12, 0
  v_dot2_f32_bf16 v52, v101, v13, v52
  v_dot2_f32_bf16 v52, v102, v14, v52
  v_dot2_f32_bf16 v52, v103, v15, v52
  buffer_load_dwordx4 v[100:103], v1, s[12:15], s59 offen offset:3072 nt
  s_waitcnt vmcnt(15)
  v_dot2_f32_bf16 v53, v104, v12, 0
  v_dot2_f32_bf16 v53, v105, v13, v53
  v_dot2_f32_bf16 v53, v106, v14, v53
  v_dot2_f32_bf16 v53, v107, v15, v53
  v_add_f32_dpp v54, v52, v52 row_ror:8 row_mask:0xf bank_mask:0x3
  s_nop 1
  v_add_f32_dpp v54, v53, v53 row_ror:8 row_mask:0xf bank_mask:0xc
  s_add_u32 s60, s59, 65536
  buffer_load_dwordx4 v[104:107], v1, s[12:15], s60 offen offset:0 nt
  s_waitcnt vmcnt(15)
  v_lshlrev_b32 v44, 16, v108
  v_and_b32 v45, v63, v108
  v_lshlrev_b32 v46, 16, v109
  v_and_b32 v47, v63, v109
  v_lshlrev_b32 v48, 16, v110
  v_and_b32 v49, v63, v110
  v_lshlrev_b32 v50, 16, v111
  v_and_b32 v51, v63, v111
  v_fmac_f32_dpp v28, v9, v44 row_newbcast:1 row_mask:0xf bank_mask:0xf
  v_fmac_f32_dpp v29, v9, v45 row_newbcast:1 row_mask:0xf bank_mask:0xf
  v_fmac_f32_dpp v30, v9, v46 row_newbcast:1 row_mask:0xf bank_mask:0xf
  v_fmac_f32_dpp v31, v9, v47 row_newbcast:1 row_mask:0xf bank_mask:0xf
  v_fmac_f32_dpp v32, v9, v48 row_newbcast:1 row_mask:0xf bank_mask:0xf
  v_fmac_f32_dpp v33, v9, v49 row_newbcast:1 row_mask:0xf bank_mask:0xf
  v_fmac_f32_dpp v34, v9, v50 row_newbcast:1 row_mask:0xf bank_mask:0xf
  v_fmac_f32_dpp v35, v9, v51 row_newbcast:1 row_mask:0xf bank_mask:0xf
  s_add_u32 s60, s62, 221184
  buffer_load_dwordx4 v[108:111], v3, s[20:23], s60 offen offset:0
  s_waitcnt vmcnt(15)
  v_dot2_f32_bf16 v52, v112, v12, 0
  v_dot2_f32_bf16 v52, v113, v13, v52
  v_dot2_f32_bf16 v52, v114, v14, v52
  v_dot2_f32_bf16 v52, v115, v15, v52
  s_add_u32 s60, s59, 65536
  buffer_load_dwordx4 v[112:115], v1, s[12:15], s60 offen offset:1024 nt
  s_waitcnt vmcnt(15)
  v_dot2_f32_bf16 v53, v116, v12, 0
  v_dot2_f32_bf16 v53, v117, v13, v53
  v_dot2_f32_bf16 v53, v118, v14, v53
  v_dot2_f32_bf16 v53, v119, v15, v53
  v_add_f32_dpp v55, v52, v52 row_ror:8 row_mask:0xf bank_mask:0x3
  s_nop 1
  v_add_f32_dpp v55, v53, v53 row_ror:8 row_mask:0xf bank_mask:0xc
  v_add_f32_dpp v56, v54, v54 row_shl:4 row_mask:0xf bank_mask:0x5
  s_nop 1
  v_add_f32_dpp v56, v55, v55 row_shr:4 row_mask:0xf bank_mask:0xa
  s_add_u32 s60, s59, 65536
  buffer_load_dwordx4 v[116:119], v1, s[12:15], s60 offen offset:2048 nt
  s_waitcnt vmcnt(15)
  v_lshlrev_b32 v44, 16, v120
  v_and_b32 v45, v63, v120
  v_lshlrev_b32 v46, 16, v121
  v_and_b32 v47, v63, v121
  v_lshlrev_b32 v48, 16, v122
  v_and_b32 v49, v63, v122
  v_lshlrev_b32 v50, 16, v123
  v_and_b32 v51, v63, v123
  v_fmac_f32_dpp v28, v9, v44 row_newbcast:2 row_mask:0xf bank_mask:0xf
  v_fmac_f32_dpp v29, v9, v45 row_newbcast:2 row_mask:0xf bank_mask:0xf
  v_fmac_f32_dpp v30, v9, v46 row_newbcast:2 row_mask:0xf bank_mask:0xf
  v_fmac_f32_dpp v31, v9, v47 row_newbcast:2 row_mask:0xf bank_mask:0xf
  v_fmac_f32_dpp v32, v9, v48 row_newbcast:2 row_mask:0xf bank_mask:0xf
  v_fmac_f32_dpp v33, v9, v49 row_newbcast:2 row_mask:0xf bank_mask:0xf
  v_fmac_f32_dpp v34, v9, v50 row_newbcast:2 row_mask:0xf bank_mask:0xf
  v_fmac_f32_dpp v35, v9, v51 row_newbcast:2 row_mask:0xf bank_mask:0xf
  s_add_u32 s60, s62, 258048
  buffer_load_dwordx4 v[120:123], v3, s[20:23], s60 offen offset:0
  s_waitcnt vmcnt(15)
  v_dot2_f32_bf16 v52, v124, v12, 0
  v_dot2_f32_bf16 v52, v125, v13, v52
  v_dot2_f32_bf16 v52, v126, v14, v52
  v_dot2_f32_bf16 v52, v127, v15, v52
  s_add_u32 s60, s59, 65536
  buffer_load_dwordx4 v[124:127], v1, s[12:15], s60 offen offset:3072 nt
  s_waitcnt vmcnt(15)
  v_dot2_f32_bf16 v53, v64, v12, 0
  v_dot2_f32_bf16 v53, v65, v13, v53
  v_dot2_f32_bf16 v53, v66, v14, v53
  v_dot2_f32_bf16 v53, v67, v15, v53
  v_add_f32_dpp v54, v52, v52 row_ror:8 row_mask:0xf bank_mask:0x3
  s_nop 1
  v_add_f32_dpp v54, v53, v53 row_ror:8 row_mask:0xf bank_mask:0xc
  s_add_u32 s60, s59, 131072
  buffer_load_dwordx4 v[64:67], v1, s[12:15], s60 offen offset:0 nt
  s_waitcnt vmcnt(15)
  v_lshlrev_b32 v44, 16, v68
  v_and_b32 v45, v63, v68
  v_lshlrev_b32 v46, 16, v69
  v_and_b32 v47, v63, v69
  v_lshlrev_b32 v48, 16, v70
  v_and_b32 v49, v63, v70
  v_lshlrev_b32 v50, 16, v71
  v_and_b32 v51, v63, v71
  v_fmac_f32_dpp v28, v9, v44 row_newbcast:3 row_mask:0xf bank_mask:0xf
  v_fmac_f32_dpp v29, v9, v45 row_newbcast:3 row_mask:0xf bank_mask:0xf
  v_fmac_f32_dpp v30, v9, v46 row_newbcast:3 row_mask:0xf bank_mask:0xf
  v_fmac_f32_dpp v31, v9, v47 row_newbcast:3 row_mask:0xf bank_mask:0xf
  v_fmac_f32_dpp v32, v9, v48 row_newbcast:3 row_mask:0xf bank_mask:0xf
  v_fmac_f32_dpp v33, v9, v49 row_newbcast:3 row_mask:0xf bank_mask:0xf
  v_fmac_f32_dpp v34, v9, v50 row_newbcast:3 row_mask:0xf bank_mask:0xf
  v_fmac_f32_dpp v35, v9, v51 row_newbcast:3 row_mask:0xf bank_mask:0xf
  s_add_u32 s60, s59, 131072
  buffer_load_dwordx4 v[68:71], v1, s[12:15], s60 offen offset:1024 nt
  s_waitcnt vmcnt(15)
  v_dot2_f32_bf16 v52, v72, v12, 0
  v_dot2_f32_bf16 v52, v73, v13, v52
  v_dot2_f32_bf16 v52, v74, v14, v52
  v_dot2_f32_bf16 v52, v75, v15, v52
  s_add_u32 s60, s62, 294912
  buffer_load_dwordx4 v[72:75], v3, s[20:23], s60 offen offset:0
  s_waitcnt vmcnt(15)
  v_dot2_f32_bf16 v53, v76, v12, 0
  v_dot2_f32_bf16 v53, v77, v13, v53
  v_dot2_f32_bf16 v53, v78, v14, v53
  v_dot2_f32_bf16 v53, v79, v15, v53
  v_add_f32_dpp v55, v52, v52 row_ror:8 row_mask:0xf bank_mask:0x3
  s_nop 1
  v_add_f32_dpp v55, v53, v53 row_ror:8 row_mask:0xf bank_mask:0xc
  v_add_f32_dpp v57, v54, v54 row_shl:4 row_mask:0xf bank_mask:0x5
  s_nop 1
  v_add_f32_dpp v57, v55, v55 row_shr:4 row_mask:0xf bank_mask:0xa
  v_add_f32_dpp v56, v56, v56 quad_perm:[2,3,0,1] row_mask:0xf bank_mask:0xf
  s_nop 0
  v_add_f32_dpp v57, v57, v57 quad_perm:[2,3,0,1] row_mask:0xf bank_mask:0xf
  v_cndmask_b32 v59, v56, v57, s[84:85]
  v_add_f32_dpp v58, v58, v58 quad_perm:[1,0,3,2] row_mask:0xf bank_mask:0xf
  s_nop 0
  v_add_f32_dpp v59, v59, v59 quad_perm:[1,0,3,2] row_mask:0xf bank_mask:0xf
  v_cndmask_b32 v52, v58, v59, s[86:87]
  s_add_u32 s60, s59, 131072
  buffer_load_dwordx4 v[76:79], v1, s[12:15], s60 offen offset:2048 nt
  v_cvt_pk_bf16_f32 v52, v52, v52
  v_lshlrev_b32 v52, 16, v52
  v_mul_f32 v52, 0x3db504f3, v52
  v_cvt_pk_bf16_f32 v52, v52, v52
  v_lshlrev_b32 v52, 16, v52
  v_mul_f32 v52, 0x3fb8aa3b, v52
  v_mov_b32 v53, v52
  s_nop 1
  v_max_f32_dpp v53, v53, v53 quad_perm:[1,0,3,2] row_mask:0xf bank_mask:0xf
  s_nop 1
  v_max_f32_dpp v53, v53, v53 quad_perm:[2,3,0,1] row_mask:0xf bank_mask:0xf
  s_nop 1
  v_max_f32_dpp v53, v53, v53 row_half_mirror row_mask:0xf bank_mask:0xf
  s_nop 1
  v_max_f32_dpp v53, v53, v53 row_ror:8 row_mask:0xf bank_mask:0xf
  v_mov_b32 v24, v53
  v_sub_f32 v26, v52, v24
  v_exp_f32 v26, v26
  s_nop 0
  v_mov_b32 v25, v26
  s_waitcnt vmcnt(15)
  v_lshlrev_b32 v44, 16, v80
  v_and_b32 v45, v63, v80
  v_lshlrev_b32 v46, 16, v81
  v_and_b32 v47, v63, v81
  v_lshlrev_b32 v48, 16, v82
  v_and_b32 v49, v63, v82
  v_lshlrev_b32 v50, 16, v83
  v_and_b32 v51, v63, v83
  v_mul_f32_dpp v16, v26, v44 row_newbcast:0 row_mask:0xf bank_mask:0xf
  v_mul_f32_dpp v17, v26, v45 row_newbcast:0 row_mask:0xf bank_mask:0xf
  v_mul_f32_dpp v18, v26, v46 row_newbcast:0 row_mask:0xf bank_mask:0xf
  v_mul_f32_dpp v19, v26, v47 row_newbcast:0 row_mask:0xf bank_mask:0xf
  v_mul_f32_dpp v20, v26, v48 row_newbcast:0 row_mask:0xf bank_mask:0xf
  v_mul_f32_dpp v21, v26, v49 row_newbcast:0 row_mask:0xf bank_mask:0xf
  v_mul_f32_dpp v22, v26, v50 row_newbcast:0 row_mask:0xf bank_mask:0xf
  v_mul_f32_dpp v23, v26, v51 row_newbcast:0 row_mask:0xf bank_mask:0xf
  s_add_u32 s60, s59, 131072
  buffer_load_dwordx4 v[80:83], v1, s[12:15], s60 offen offset:3072 nt
  s_waitcnt vmcnt(15)
  v_lshlrev_b32 v44, 16, v84
  v_and_b32 v45, v63, v84
  v_lshlrev_b32 v46, 16, v85
  v_and_b32 v47, v63, v85
  v_lshlrev_b32 v48, 16, v86
  v_and_b32 v49, v63, v86
  v_lshlrev_b32 v50, 16, v87
  v_and_b32 v51, v63, v87
  v_fmac_f32_dpp v28, v9, v44 row_newbcast:4 row_mask:0xf bank_mask:0xf
  v_fmac_f32_dpp v29, v9, v45 row_newbcast:4 row_mask:0xf bank_mask:0xf
  v_fmac_f32_dpp v30, v9, v46 row_newbcast:4 row_mask:0xf bank_mask:0xf
  v_fmac_f32_dpp v31, v9, v47 row_newbcast:4 row_mask:0xf bank_mask:0xf
  v_fmac_f32_dpp v32, v9, v48 row_newbcast:4 row_mask:0xf bank_mask:0xf
  v_fmac_f32_dpp v33, v9, v49 row_newbcast:4 row_mask:0xf bank_mask:0xf
  v_fmac_f32_dpp v34, v9, v50 row_newbcast:4 row_mask:0xf bank_mask:0xf
  v_fmac_f32_dpp v35, v9, v51 row_newbcast:4 row_mask:0xf bank_mask:0xf
  buffer_load_dwordx4 v[84:87], v3, s[24:27], s62 offen offset:0
  s_waitcnt vmcnt(15)
  v_lshlrev_b32 v44, 16, v88
  v_and_b32 v45, v63, v88
  v_lshlrev_b32 v46, 16, v89
  v_and_b32 v47, v63, v89
  v_lshlrev_b32 v48, 16, v90
  v_and_b32 v49, v63, v90
  v_lshlrev_b32 v50, 16, v91
  v_and_b32 v51, v63, v91
  v_fmac_f32_dpp v16, v26, v44 row_newbcast:8 row_mask:0xf bank_mask:0xf
  v_fmac_f32_dpp v17, v26, v45 row_newbcast:8 row_mask:0xf bank_mask:0xf
  v_fmac_f32_dpp v18, v26, v46 row_newbcast:8 row_mask:0xf bank_mask:0xf
  v_fmac_f32_dpp v19, v26, v47 row_newbcast:8 row_mask:0xf bank_mask:0xf
  v_fmac_f32_dpp v20, v26, v48 row_newbcast:8 row_mask:0xf bank_mask:0xf
  v_fmac_f32_dpp v21, v26, v49 row_newbcast:8 row_mask:0xf bank_mask:0xf
  v_fmac_f32_dpp v22, v26, v50 row_newbcast:8 row_mask:0xf bank_mask:0xf
  v_fmac_f32_dpp v23, v26, v51 row_newbcast:8 row_mask:0xf bank_mask:0xf
  s_add_u32 s60, s59, 196608
  buffer_load_dwordx4 v[88:91], v1, s[12:15], s60 offen offset:0 nt
  s_waitcnt vmcnt(15)
  v_lshlrev_b32 v44, 16, v92
  v_and_b32 v45, v63, v92
  v_lshlrev_b32 v46, 16, v93
  v_and_b32 v47, v63, v93
  v_lshlrev_b32 v48, 16, v94
  v_and_b32 v49, v63, v94
  v_lshlrev_b32 v50, 16, v95
  v_and_b32 v51, v63, v95
  v_fmac_f32_dpp v16, v26, v44 row_newbcast:4 row_mask:0xf bank_mask:0xf
  v_fmac_f32_dpp v17, v26, v45 row_newbcast:4 row_mask:0xf bank_mask:0xf
  v_fmac_f32_dpp v18, v26, v46 row_newbcast:4 row_mask:0xf bank_mask:0xf
  v_fmac_f32_dpp v19, v26, v47 row_newbcast:4 row_mask:0xf bank_mask:0xf
  v_fmac_f32_dpp v20, v26, v48 row_newbcast:4 row_mask:0xf bank_mask:0xf
  v_fmac_f32_dpp v21, v26, v49 row_newbcast:4 row_mask:0xf bank_mask:0xf
  v_fmac_f32_dpp v22, v26, v50 row_newbcast:4 row_mask:0xf bank_mask:0xf
  v_fmac_f32_dpp v23, v26, v51 row_newbcast:4 row_mask:0xf bank_mask:0xf
  s_add_u32 s60, s59, 196608
  buffer_load_dwordx4 v[92:95], v1, s[12:15], s60 offen offset:1024 nt
  s_waitcnt vmcnt(15)
  v_lshlrev_b32 v44, 16, v96
  v_and_b32 v45, v63, v96
  v_lshlrev_b32 v46, 16, v97
  v_and_b32 v47, v63, v97
  v_lshlrev_b32 v48, 16, v98
  v_and_b32 v49, v63, v98
  v_lshlrev_b32 v50, 16, v99
  v_and_b32 v51, v63, v99
  v_fmac_f32_dpp v28, v9, v44 row_newbcast:5 row_mask:0xf bank_mask:0xf
  v_fmac_f32_dpp v29, v9, v45 row_newbcast:5 row_mask:0xf bank_mask:0xf
  v_fmac_f32_dpp v30, v9, v46 row_newbcast:5 row_mask:0xf bank_mask:0xf
  v_fmac_f32_dpp v31, v9, v47 row_newbcast:5 row_mask:0xf bank_mask:0xf
  v_fmac_f32_dpp v32, v9, v48 row_newbcast:5 row_mask:0xf bank_mask:0xf
  v_fmac_f32_dpp v33, v9, v49 row_newbcast:5 row_mask:0xf bank_mask:0xf
  v_fmac_f32_dpp v34, v9, v50 row_newbcast:5 row_mask:0xf bank_mask:0xf
  v_fmac_f32_dpp v35, v9, v51 row_newbcast:5 row_mask:0xf bank_mask:0xf
  s_add_u32 s60, s62, 36864
  buffer_load_dwordx4 v[96:99], v3, s[24:27], s60 offen offset:0
  s_waitcnt vmcnt(15)
  v_lshlrev_b32 v44, 16, v100
  v_and_b32 v45, v63, v100
  v_lshlrev_b32 v46, 16, v101
  v_and_b32 v47, v63, v101
  v_lshlrev_b32 v48, 16, v102
  v_and_b32 v49, v63, v102
  v_lshlrev_b32 v50, 16, v103
  v_and_b32 v51, v63, v103
  v_fmac_f32_dpp v16, v26, v44 row_newbcast:12 row_mask:0xf bank_mask:0xf
  v_fmac_f32_dpp v17, v26, v45 row_newbcast:12 row_mask:0xf bank_mask:0xf
  v_fmac_f32_dpp v18, v26, v46 row_newbcast:12 row_mask:0xf bank_mask:0xf
  v_fmac_f32_dpp v19, v26, v47 row_newbcast:12 row_mask:0xf bank_mask:0xf
  v_fmac_f32_dpp v20, v26, v48 row_newbcast:12 row_mask:0xf bank_mask:0xf
  v_fmac_f32_dpp v21, v26, v49 row_newbcast:12 row_mask:0xf bank_mask:0xf
  v_fmac_f32_dpp v22, v26, v50 row_newbcast:12 row_mask:0xf bank_mask:0xf
  v_fmac_f32_dpp v23, v26, v51 row_newbcast:12 row_mask:0xf bank_mask:0xf
  s_add_u32 s60, s59, 196608
  buffer_load_dwordx4 v[100:103], v1, s[12:15], s60 offen offset:2048 nt
  s_waitcnt vmcnt(15)
  v_lshlrev_b32 v44, 16, v104
  v_and_b32 v45, v63, v104
  v_lshlrev_b32 v46, 16, v105
  v_and_b32 v47, v63, v105
  v_lshlrev_b32 v48, 16, v106
  v_and_b32 v49, v63, v106
  v_lshlrev_b32 v50, 16, v107
  v_and_b32 v51, v63, v107
  v_fmac_f32_dpp v16, v26, v44 row_newbcast:2 row_mask:0xf bank_mask:0xf
  v_fmac_f32_dpp v17, v26, v45 row_newbcast:2 row_mask:0xf bank_mask:0xf
  v_fmac_f32_dpp v18, v26, v46 row_newbcast:2 row_mask:0xf bank_mask:0xf
  v_fmac_f32_dpp v19, v26, v47 row_newbcast:2 row_mask:0xf bank_mask:0xf
  v_fmac_f32_dpp v20, v26, v48 row_newbcast:2 row_mask:0xf bank_mask:0xf
  v_fmac_f32_dpp v21, v26, v49 row_newbcast:2 row_mask:0xf bank_mask:0xf
  v_fmac_f32_dpp v22, v26, v50 row_newbcast:2 row_mask:0xf bank_mask:0xf
  v_fmac_f32_dpp v23, v26, v51 row_newbcast:2 row_mask:0xf bank_mask:0xf
  s_add_u32 s60, s59, 196608
  buffer_load_dwordx4 v[104:107], v1, s[12:15], s60 offen offset:3072 nt
  s_waitcnt vmcnt(15)
  v_lshlrev_b32 v44, 16, v108
  v_and_b32 v45, v63, v108
  v_lshlrev_b32 v46, 16, v109
  v_and_b32 v47, v63, v109
  v_lshlrev_b32 v48, 16, v110
  v_and_b32 v49, v63, v110
  v_lshlrev_b32 v50, 16, v111
  v_and_b32 v51, v63, v111
  v_fmac_f32_dpp v28, v9, v44 row_newbcast:6 row_mask:0xf bank_mask:0xf
  v_fmac_f32_dpp v29, v9, v45 row_newbcast:6 row_mask:0xf bank_mask:0xf
  v_fmac_f32_dpp v30, v9, v46 row_newbcast:6 row_mask:0xf bank_mask:0xf
  v_fmac_f32_dpp v31, v9, v47 row_newbcast:6 row_mask:0xf bank_mask:0xf
  v_fmac_f32_dpp v32, v9, v48 row_newbcast:6 row_mask:0xf bank_mask:0xf
  v_fmac_f32_dpp v33, v9, v49 row_newbcast:6 row_mask:0xf bank_mask:0xf
  v_fmac_f32_dpp v34, v9, v50 row_newbcast:6 row_mask:0xf bank_mask:0xf
  v_fmac_f32_dpp v35, v9, v51 row_newbcast:6 row_mask:0xf bank_mask:0xf
  s_add_u32 s60, s62, 73728
  buffer_load_dwordx4 v[108:111], v3, s[24:27], s60 offen offset:0
  s_waitcnt vmcnt(15)
  v_lshlrev_b32 v44, 16, v112
  v_and_b32 v45, v63, v112
  v_lshlrev_b32 v46, 16, v113
  v_and_b32 v47, v63, v113
  v_lshlrev_b32 v48, 16, v114
  v_and_b32 v49, v63, v114
  v_lshlrev_b32 v50, 16, v115
  v_and_b32 v51, v63, v115
  v_fmac_f32_dpp v16, v26, v44 row_newbcast:10 row_mask:0xf bank_mask:0xf
  v_fmac_f32_dpp v17, v26, v45 row_newbcast:10 row_mask:0xf bank_mask:0xf
  v_fmac_f32_dpp v18, v26, v46 row_newbcast:10 row_mask:0xf bank_mask:0xf
  v_fmac_f32_dpp v19, v26, v47 row_newbcast:10 row_mask:0xf bank_mask:0xf
  v_fmac_f32_dpp v20, v26, v48 row_newbcast:10 row_mask:0xf bank_mask:0xf
  v_fmac_f32_dpp v21, v26, v49 row_newbcast:10 row_mask:0xf bank_mask:0xf
  v_fmac_f32_dpp v22, v26, v50 row_newbcast:10 row_mask:0xf bank_mask:0xf
  v_fmac_f32_dpp v23, v26, v51 row_newbcast:10 row_mask:0xf bank_mask:0xf
  s_add_u32 s60, s59, 262144
  buffer_load_dwordx4 v[112:115], v1, s[8:11], s60 offen offset:0 nt
  s_waitcnt vmcnt(15)
  v_lshlrev_b32 v44, 16, v116
  v_and_b32 v45, v63, v116
  v_lshlrev_b32 v46, 16, v117
  v_and_b32 v47, v63, v117
  v_lshlrev_b32 v48, 16, v118
  v_and_b32 v49, v63, v118
  v_lshlrev_b32 v50, 16, v119
  v_and_b32 v51, v63, v119
  v_fmac_f32_dpp v16, v26, v44 row_newbcast:6 row_mask:0xf bank_mask:0xf
  v_fmac_f32_dpp v17, v26, v45 row_newbcast:6 row_mask:0xf bank_mask:0xf
  v_fmac_f32_dpp v18, v26, v46 row_newbcast:6 row_mask:0xf bank_mask:0xf
  v_fmac_f32_dpp v19, v26, v47 row_newbcast:6 row_mask:0xf bank_mask:0xf
  v_fmac_f32_dpp v20, v26, v48 row_newbcast:6 row_mask:0xf bank_mask:0xf
  v_fmac_f32_dpp v21, v26, v49 row_newbcast:6 row_mask:0xf bank_mask:0xf
  v_fmac_f32_dpp v22, v26, v50 row_newbcast:6 row_mask:0xf bank_mask:0xf
  v_fmac_f32_dpp v23, v26, v51 row_newbcast:6 row_mask:0xf bank_mask:0xf
  s_add_u32 s60, s59, 262144
  buffer_load_dwordx4 v[116:119], v1, s[8:11], s60 offen offset:1024 nt
  s_waitcnt vmcnt(15)
  v_lshlrev_b32 v44, 16, v120
  v_and_b32 v45, v63, v120
  v_lshlrev_b32 v46, 16, v121
  v_and_b32 v47, v63, v121
  v_lshlrev_b32 v48, 16, v122
  v_and_b32 v49, v63, v122
  v_lshlrev_b32 v50, 16, v123
  v_and_b32 v51, v63, v123
  v_fmac_f32_dpp v28, v9, v44 row_newbcast:7 row_mask:0xf bank_mask:0xf
  v_fmac_f32_dpp v29, v9, v45 row_newbcast:7 row_mask:0xf bank_mask:0xf
  v_fmac_f32_dpp v30, v9, v46 row_newbcast:7 row_mask:0xf bank_mask:0xf
  v_fmac_f32_dpp v31, v9, v47 row_newbcast:7 row_mask:0xf bank_mask:0xf
  v_fmac_f32_dpp v32, v9, v48 row_newbcast:7 row_mask:0xf bank_mask:0xf
  v_fmac_f32_dpp v33, v9, v49 row_newbcast:7 row_mask:0xf bank_mask:0xf
  v_fmac_f32_dpp v34, v9, v50 row_newbcast:7 row_mask:0xf bank_mask:0xf
  v_fmac_f32_dpp v35, v9, v51 row_newbcast:7 row_mask:0xf bank_mask:0xf
  s_add_u32 s60, s59, 262144
  buffer_load_dwordx4 v[120:123], v1, s[8:11], s60 offen offset:2048 nt
  s_waitcnt vmcnt(15)
  v_lshlrev_b32 v44, 16, v124
  v_and_b32 v45, v63, v124
  v_lshlrev_b32 v46, 16, v125
  v_and_b32 v47, v63, v125
  v_lshlrev_b32 v48, 16, v126
  v_and_b32 v49, v63, v126
  v_lshlrev_b32 v50, 16, v127
  v_and_b32 v51, v63, v127
  v_fmac_f32_dpp v16, v26, v44 row_newbcast:14 row_mask:0xf bank_mask:0xf
  v_fmac_f32_dpp v17, v26, v45 row_newbcast:14 row_mask:0xf bank_mask:0xf
  v_fmac_f32_dpp v18, v26, v46 row_newbcast:14 row_mask:0xf bank_mask:0xf
  v_fmac_f32_dpp v19, v26, v47 row_newbcast:14 row_mask:0xf bank_mask:0xf
  v_fmac_f32_dpp v20, v26, v48 row_newbcast:14 row_mask:0xf bank_mask:0xf
  v_fmac_f32_dpp v21, v26, v49 row_newbcast:14 row_mask:0xf bank_mask:0xf
  v_fmac_f32_dpp v22, v26, v50 row_newbcast:14 row_mask:0xf bank_mask:0xf
  v_fmac_f32_dpp v23, v26, v51 row_newbcast:14 row_mask:0xf bank_mask:0xf
  s_add_u32 s60, s62, 110592
  buffer_load_dwordx4 v[124:127], v3, s[24:27], s60 offen offset:0
  s_waitcnt vmcnt(15)
  v_lshlrev_b32 v44, 16, v64
  v_and_b32 v45, v63, v64
  v_lshlrev_b32 v46, 16, v65
  v_and_b32 v47, v63, v65
  v_lshlrev_b32 v48, 16, v66
  v_and_b32 v49, v63, v66
  v_lshlrev_b32 v50, 16, v67
  v_and_b32 v51, v63, v67
  v_fmac_f32_dpp v16, v26, v44 row_newbcast:1 row_mask:0xf bank_mask:0xf
  v_fmac_f32_dpp v17, v26, v45 row_newbcast:1 row_mask:0xf bank_mask:0xf
  v_fmac_f32_dpp v18, v26, v46 row_newbcast:1 row_mask:0xf bank_mask:0xf
  v_fmac_f32_dpp v19, v26, v47 row_newbcast:1 row_mask:0xf bank_mask:0xf
  v_fmac_f32_dpp v20, v26, v48 row_newbcast:1 row_mask:0xf bank_mask:0xf
  v_fmac_f32_dpp v21, v26, v49 row_newbcast:1 row_mask:0xf bank_mask:0xf
  v_fmac_f32_dpp v22, v26, v50 row_newbcast:1 row_mask:0xf bank_mask:0xf
  v_fmac_f32_dpp v23, v26, v51 row_newbcast:1 row_mask:0xf bank_mask:0xf
  s_add_u32 s60, s59, 262144
  buffer_load_dwordx4 v[64:67], v1, s[8:11], s60 offen offset:3072 nt
  s_waitcnt vmcnt(15)
  v_lshlrev_b32 v44, 16, v68
  v_and_b32 v45, v63, v68
  v_lshlrev_b32 v46, 16, v69
  v_and_b32 v47, v63, v69
  v_lshlrev_b32 v48, 16, v70
  v_and_b32 v49, v63, v70
  v_lshlrev_b32 v50, 16, v71
  v_and_b32 v51, v63, v71
  v_fmac_f32_dpp v16, v26, v44 row_newbcast:9 row_mask:0xf bank_mask:0xf
  v_fmac_f32_dpp v17, v26, v45 row_newbcast:9 row_mask:0xf bank_mask:0xf
  v_fmac_f32_dpp v18, v26, v46 row_newbcast:9 row_mask:0xf bank_mask:0xf
  v_fmac_f32_dpp v19, v26, v47 row_newbcast:9 row_mask:0xf bank_mask:0xf
  v_fmac_f32_dpp v20, v26, v48 row_newbcast:9 row_mask:0xf bank_mask:0xf
  v_fmac_f32_dpp v21, v26, v49 row_newbcast:9 row_mask:0xf bank_mask:0xf
  v_fmac_f32_dpp v22, v26, v50 row_newbcast:9 row_mask:0xf bank_mask:0xf
  v_fmac_f32_dpp v23, v26, v51 row_newbcast:9 row_mask:0xf bank_mask:0xf
  s_add_u32 s60, s59, 327680
  buffer_load_dwordx4 v[68:71], v1, s[8:11], s60 offen offset:0 nt
  s_waitcnt vmcnt(15)
  v_lshlrev_b32 v44, 16, v72
  v_and_b32 v45, v63, v72
  v_lshlrev_b32 v46, 16, v73
  v_and_b32 v47, v63, v73
  v_lshlrev_b32 v48, 16, v74
  v_and_b32 v49, v63, v74
  v_lshlrev_b32 v50, 16, v75
  v_and_b32 v51, v63, v75
  v_fmac_f32_dpp v28, v9, v44 row_newbcast:8 row_mask:0xf bank_mask:0xf
  v_fmac_f32_dpp v29, v9, v45 row_newbcast:8 row_mask:0xf bank_mask:0xf
  v_fmac_f32_dpp v30, v9, v46 row_newbcast:8 row_mask:0xf bank_mask:0xf
  v_fmac_f32_dpp v31, v9, v47 row_newbcast:8 row_mask:0xf bank_mask:0xf
  v_fmac_f32_dpp v32, v9, v48 row_newbcast:8 row_mask:0xf bank_mask:0xf
  v_fmac_f32_dpp v33, v9, v49 row_newbcast:8 row_mask:0xf bank_mask:0xf
  v_fmac_f32_dpp v34, v9, v50 row_newbcast:8 row_mask:0xf bank_mask:0xf
  v_fmac_f32_dpp v35, v9, v51 row_newbcast:8 row_mask:0xf bank_mask:0xf
  s_add_u32 s60, s62, 147456
  buffer_load_dwordx4 v[72:75], v3, s[24:27], s60 offen offset:0
  v_permlane32_swap_b32 v28, v32
  v_permlane32_swap_b32 v29, v33
  v_permlane32_swap_b32 v30, v34
  v_permlane32_swap_b32 v31, v35
  v_add_f32 v28, v28, v32
  v_add_f32 v29, v29, v33
  v_add_f32 v30, v30, v34
  v_add_f32 v31, v31, v35
  s_nop 0
  v_permlane16_swap_b32 v28, v30
  v_permlane16_swap_b32 v29, v31
  v_add_f32 v28, v28, v30
  v_add_f32 v29, v29, v31
  ds_write_b64 v60, v[28:29] offset:8192
  s_waitcnt vmcnt(15)
  v_lshlrev_b32 v44, 16, v76
  v_and_b32 v45, v63, v76
  v_lshlrev_b32 v46, 16, v77
  v_and_b32 v47, v63, v77
  v_lshlrev_b32 v48, 16, v78
  v_and_b32 v49, v63, v78
  v_lshlrev_b32 v50, 16, v79
  v_and_b32 v51, v63, v79
  v_fmac_f32_dpp v16, v26, v44 row_newbcast:5 row_mask:0xf bank_mask:0xf
  v_fmac_f32_dpp v17, v26, v45 row_newbcast:5 row_mask:0xf bank_mask:0xf
  v_fmac_f32_dpp v18, v26, v46 row_newbcast:5 row_mask:0xf bank_mask:0xf
  v_fmac_f32_dpp v19, v26, v47 row_newbcast:5 row_mask:0xf bank_mask:0xf
  v_fmac_f32_dpp v20, v26, v48 row_newbcast:5 row_mask:0xf bank_mask:0xf
  v_fmac_f32_dpp v21, v26, v49 row_newbcast:5 row_mask:0xf bank_mask:0xf
  v_fmac_f32_dpp v22, v26, v50 row_newbcast:5 row_mask:0xf bank_mask:0xf
  v_fmac_f32_dpp v23, v26, v51 row_newbcast:5 row_mask:0xf bank_mask:0xf
  s_add_u32 s60, s59, 327680
  buffer_load_dwordx4 v[76:79], v1, s[8:11], s60 offen offset:1024 nt
  s_waitcnt vmcnt(15)
  v_lshlrev_b32 v44, 16, v80
  v_and_b32 v45, v63, v80
  v_lshlrev_b32 v46, 16, v81
  v_and_b32 v47, v63, v81
  v_lshlrev_b32 v48, 16, v82
  v_and_b32 v49, v63, v82
  v_lshlrev_b32 v50, 16, v83
  v_and_b32 v51, v63, v83
  v_fmac_f32_dpp v16, v26, v44 row_newbcast:13 row_mask:0xf bank_mask:0xf
  v_fmac_f32_dpp v17, v26, v45 row_newbcast:13 row_mask:0xf bank_mask:0xf
  v_fmac_f32_dpp v18, v26, v46 row_newbcast:13 row_mask:0xf bank_mask:0xf
  v_fmac_f32_dpp v19, v26, v47 row_newbcast:13 row_mask:0xf bank_mask:0xf
  v_fmac_f32_dpp v20, v26, v48 row_newbcast:13 row_mask:0xf bank_mask:0xf
  v_fmac_f32_dpp v21, v26, v49 row_newbcast:13 row_mask:0xf bank_mask:0xf
  v_fmac_f32_dpp v22, v26, v50 row_newbcast:13 row_mask:0xf bank_mask:0xf
  v_fmac_f32_dpp v23, v26, v51 row_newbcast:13 row_mask:0xf bank_mask:0xf
  s_add_u32 s60, s59, 327680
  buffer_load_dwordx4 v[80:83], v1, s[8:11], s60 offen offset:2048 nt
  s_waitcnt vmcnt(15)
  v_lshlrev_b32 v44, 16, v84
  v_and_b32 v45, v63, v84
  v_lshlrev_b32 v46, 16, v85
  v_and_b32 v47, v63, v85
  v_lshlrev_b32 v48, 16, v86
  v_and_b32 v49, v63, v86
  v_lshlrev_b32 v50, 16, v87
  v_and_b32 v51, v63, v87
  v_mul_f32_dpp v28, v9, v44 row_newbcast:0 row_mask:0xf bank_mask:0xf
  v_mul_f32_dpp v29, v9, v45 row_newbcast:0 row_mask:0xf bank_mask:0xf
  v_mul_f32_dpp v30, v9, v46 row_newbcast:0 row_mask:0xf bank_mask:0xf
  v_mul_f32_dpp v31, v9, v47 row_newbcast:0 row_mask:0xf bank_mask:0xf
  v_mul_f32_dpp v32, v9, v48 row_newbcast:0 row_mask:0xf bank_mask:0xf
  v_mul_f32_dpp v33, v9, v49 row_newbcast:0 row_mask:0xf bank_mask:0xf
  v_mul_f32_dpp v34, v9, v50 row_newbcast:0 row_mask:0xf bank_mask:0xf
  v_mul_f32_dpp v35, v9, v51 row_newbcast:0 row_mask:0xf bank_mask:0xf
  s_add_u32 s60, s62, 184320
  buffer_load_dwordx4 v[84:87], v3, s[24:27], s60 offen offset:0
  s_waitcnt vmcnt(15)
  v_lshlrev_b32 v44, 16, v88
  v_and_b32 v45, v63, v88
  v_lshlrev_b32 v46, 16, v89
  v_and_b32 v47, v63, v89
  v_lshlrev_b32 v48, 16, v90
  v_and_b32 v49, v63, v90
  v_lshlrev_b32 v50, 16, v91
  v_and_b32 v51, v63, v91
  v_fmac_f32_dpp v16, v26, v44 row_newbcast:3 row_mask:0xf bank_mask:0xf
  v_fmac_f32_dpp v17, v26, v45 row_newbcast:3 row_mask:0xf bank_mask:0xf
  v_fmac_f32_dpp v18, v26, v46 row_newbcast:3 row_mask:0xf bank_mask:0xf
  v_fmac_f32_dpp v19, v26, v47 row_newbcast:3 row_mask:0xf bank_mask:0xf
  v_fmac_f32_dpp v20, v26, v48 row_newbcast:3 row_mask:0xf bank_mask:0xf
  v_fmac_f32_dpp v21, v26, v49 row_newbcast:3 row_mask:0xf bank_mask:0xf
  v_fmac_f32_dpp v22, v26, v50 row_newbcast:3 row_mask:0xf bank_mask:0xf
  v_fmac_f32_dpp v23, v26, v51 row_newbcast:3 row_mask:0xf bank_mask:0xf
  s_add_u32 s60, s59, 327680
  buffer_load_dwordx4 v[88:91], v1, s[8:11], s60 offen offset:3072 nt
  s_waitcnt vmcnt(15)
  v_lshlrev_b32 v44, 16, v92
  v_and_b32 v45, v63, v92
  v_lshlrev_b32 v46, 16, v93
  v_and_b32 v47, v63, v93
  v_lshlrev_b32 v48, 16, v94
  v_and_b32 v49, v63, v94
  v_lshlrev_b32 v50, 16, v95
  v_and_b32 v51, v63, v95
  v_fmac_f32_dpp v16, v26, v44 row_newbcast:11 row_mask:0xf bank_mask:0xf
  v_fmac_f32_dpp v17, v26, v45 row_newbcast:11 row_mask:0xf bank_mask:0xf
  v_fmac_f32_dpp v18, v26, v46 row_newbcast:11 row_mask:0xf bank_mask:0xf
  v_fmac_f32_dpp v19, v26, v47 row_newbcast:11 row_mask:0xf bank_mask:0xf
  v_fmac_f32_dpp v20, v26, v48 row_newbcast:11 row_mask:0xf bank_mask:0xf
  v_fmac_f32_dpp v21, v26, v49 row_newbcast:11 row_mask:0xf bank_mask:0xf
  v_fmac_f32_dpp v22, v26, v50 row_newbcast:11 row_mask:0xf bank_mask:0xf
  v_fmac_f32_dpp v23, v26, v51 row_newbcast:11 row_mask:0xf bank_mask:0xf
  s_add_u32 s60, s59, 393216
  buffer_load_dwordx4 v[92:95], v1, s[8:11], s60 offen offset:0 nt
  s_waitcnt vmcnt(15)
  v_lshlrev_b32 v44, 16, v96
  v_and_b32 v45, v63, v96
  v_lshlrev_b32 v46, 16, v97
  v_and_b32 v47, v63, v97
  v_lshlrev_b32 v48, 16, v98
  v_and_b32 v49, v63, v98
  v_lshlrev_b32 v50, 16, v99
  v_and_b32 v51, v63, v99
  v_fmac_f32_dpp v28, v9, v44 row_newbcast:1 row_mask:0xf bank_mask:0xf
  v_fmac_f32_dpp v29, v9, v45 row_newbcast:1 row_mask:0xf bank_mask:0xf
  v_fmac_f32_dpp v30, v9, v46 row_newbcast:1 row_mask:0xf bank_mask:0xf
  v_fmac_f32_dpp v31, v9, v47 row_newbcast:1 row_mask:0xf bank_mask:0xf
  v_fmac_f32_dpp v32, v9, v48 row_newbcast:1 row_mask:0xf bank_mask:0xf
  v_fmac_f32_dpp v33, v9, v49 row_newbcast:1 row_mask:0xf bank_mask:0xf
  v_fmac_f32_dpp v34, v9, v50 row_newbcast:1 row_mask:0xf bank_mask:0xf
  v_fmac_f32_dpp v35, v9, v51 row_newbcast:1 row_mask:0xf bank_mask:0xf
  s_add_u32 s60, s62, 221184
  buffer_load_dwordx4 v[96:99], v3, s[24:27], s60 offen offset:0
  s_waitcnt vmcnt(15)
  v_lshlrev_b32 v44, 16, v100
  v_and_b32 v45, v63, v100
  v_lshlrev_b32 v46, 16, v101
  v_and_b32 v47, v63, v101
  v_lshlrev_b32 v48, 16, v102
  v_and_b32 v49, v63, v102
  v_lshlrev_b32 v50, 16, v103
  v_and_b32 v51, v63, v103
  v_fmac_f32_dpp v16, v26, v44 row_newbcast:7 row_mask:0xf bank_mask:0xf
  v_fmac_f32_dpp v17, v26, v45 row_newbcast:7 row_mask:0xf bank_mask:0xf
  v_fmac_f32_dpp v18, v26, v46 row_newbcast:7 row_mask:0xf bank_mask:0xf
  v_fmac_f32_dpp v19, v26, v47 row_newbcast:7 row_mask:0xf bank_mask:0xf
  v_fmac_f32_dpp v20, v26, v48 row_newbcast:7 row_mask:0xf bank_mask:0xf
  v_fmac_f32_dpp v21, v26, v49 row_newbcast:7 row_mask:0xf bank_mask:0xf
  v_fmac_f32_dpp v22, v26, v50 row_newbcast:7 row_mask:0xf bank_mask:0xf
  v_fmac_f32_dpp v23, v26, v51 row_newbcast:7 row_mask:0xf bank_mask:0xf
  s_add_u32 s60, s59, 393216
  buffer_load_dwordx4 v[100:103], v1, s[8:11], s60 offen offset:1024 nt
  s_waitcnt vmcnt(15)
  v_lshlrev_b32 v44, 16, v104
  v_and_b32 v45, v63, v104
  v_lshlrev_b32 v46, 16, v105
  v_and_b32 v47, v63, v105
  v_lshlrev_b32 v48, 16, v106
  v_and_b32 v49, v63, v106
  v_lshlrev_b32 v50, 16, v107
  v_and_b32 v51, v63, v107
  v_fmac_f32_dpp v16, v26, v44 row_newbcast:15 row_mask:0xf bank_mask:0xf
  v_fmac_f32_dpp v17, v26, v45 row_newbcast:15 row_mask:0xf bank_mask:0xf
  v_fmac_f32_dpp v18, v26, v46 row_newbcast:15 row_mask:0xf bank_mask:0xf
  v_fmac_f32_dpp v19, v26, v47 row_newbcast:15 row_mask:0xf bank_mask:0xf
  v_fmac_f32_dpp v20, v26, v48 row_newbcast:15 row_mask:0xf bank_mask:0xf
  v_fmac_f32_dpp v21, v26, v49 row_newbcast:15 row_mask:0xf bank_mask:0xf
  v_fmac_f32_dpp v22, v26, v50 row_newbcast:15 row_mask:0xf bank_mask:0xf
  v_fmac_f32_dpp v23, v26, v51 row_newbcast:15 row_mask:0xf bank_mask:0xf
  s_add_u32 s60, s59, 393216
  buffer_load_dwordx4 v[104:107], v1, s[8:11], s60 offen offset:2048 nt
  s_waitcnt vmcnt(15)
  v_lshlrev_b32 v44, 16, v108
  v_and_b32 v45, v63, v108
  v_lshlrev_b32 v46, 16, v109
  v_and_b32 v47, v63, v109
  v_lshlrev_b32 v48, 16, v110
  v_and_b32 v49, v63, v110
  v_lshlrev_b32 v50, 16, v111
  v_and_b32 v51, v63, v111
  v_fmac_f32_dpp v28, v9, v44 row_newbcast:2 row_mask:0xf bank_mask:0xf
  v_fmac_f32_dpp v29, v9, v45 row_newbcast:2 row_mask:0xf bank_mask:0xf
  v_fmac_f32_dpp v30, v9, v46 row_newbcast:2 row_mask:0xf bank_mask:0xf
  v_fmac_f32_dpp v31, v9, v47 row_newbcast:2 row_mask:0xf bank_mask:0xf
  v_fmac_f32_dpp v32, v9, v48 row_newbcast:2 row_mask:0xf bank_mask:0xf
  v_fmac_f32_dpp v33, v9, v49 row_newbcast:2 row_mask:0xf bank_mask:0xf
  v_fmac_f32_dpp v34, v9, v50 row_newbcast:2 row_mask:0xf bank_mask:0xf
  v_fmac_f32_dpp v35, v9, v51 row_newbcast:2 row_mask:0xf bank_mask:0xf
  s_add_u32 s60, s59, 393216
  buffer_load_dwordx4 v[108:111], v1, s[8:11], s60 offen offset:3072 nt
  s_waitcnt vmcnt(15)
  v_dot2_f32_bf16 v52, v112, v12, 0
  v_dot2_f32_bf16 v52, v113, v13, v52
  v_dot2_f32_bf16 v52, v114, v14, v52
  v_dot2_f32_bf16 v52, v115, v15, v52
  s_add_u32 s60, s62, 258048
  buffer_load_dwordx4 v[112:115], v3, s[24:27], s60 offen offset:0
  s_waitcnt vmcnt(15)
  v_dot2_f32_bf16 v53, v116, v12, 0
  v_dot2_f32_bf16 v53, v117, v13, v53
  v_dot2_f32_bf16 v53, v118, v14, v53
  v_dot2_f32_bf16 v53, v119, v15, v53
  v_add_f32_dpp v54, v52, v52 row_ror:8 row_mask:0xf bank_mask:0x3
  s_nop 1
  v_add_f32_dpp v54, v53, v53 row_ror:8 row_mask:0xf bank_mask:0xc
  s_add_u32 s60, s59, 458752
  buffer_load_dwordx4 v[116:119], v1, s[8:11], s60 offen offset:0 nt
  s_waitcnt vmcnt(15)
  v_dot2_f32_bf16 v52, v120, v12, 0
  v_dot2_f32_bf16 v52, v121, v13, v52
  v_dot2_f32_bf16 v52, v122, v14, v52
  v_dot2_f32_bf16 v52, v123, v15, v52
  s_add_u32 s60, s59, 458752
  buffer_load_dwordx4 v[120:123], v1, s[8:11], s60 offen offset:1024 nt
  s_waitcnt vmcnt(15)
  v_lshlrev_b32 v44, 16, v124
  v_and_b32 v45, v63, v124
  v_lshlrev_b32 v46, 16, v125
  v_and_b32 v47, v63, v125
  v_lshlrev_b32 v48, 16, v126
  v_and_b32 v49, v63, v126
  v_lshlrev_b32 v50, 16, v127
  v_and_b32 v51, v63, v127
  v_fmac_f32_dpp v28, v9, v44 row_newbcast:3 row_mask:0xf bank_mask:0xf
  v_fmac_f32_dpp v29, v9, v45 row_newbcast:3 row_mask:0xf bank_mask:0xf
  v_fmac_f32_dpp v30, v9, v46 row_newbcast:3 row_mask:0xf bank_mask:0xf
  v_fmac_f32_dpp v31, v9, v47 row_newbcast:3 row_mask:0xf bank_mask:0xf
  v_fmac_f32_dpp v32, v9, v48 row_newbcast:3 row_mask:0xf bank_mask:0xf
  v_fmac_f32_dpp v33, v9, v49 row_newbcast:3 row_mask:0xf bank_mask:0xf
  v_fmac_f32_dpp v34, v9, v50 row_newbcast:3 row_mask:0xf bank_mask:0xf
  v_fmac_f32_dpp v35, v9, v51 row_newbcast:3 row_mask:0xf bank_mask:0xf
  s_add_u32 s60, s62, 294912
  buffer_load_dwordx4 v[124:127], v3, s[24:27], s60 offen offset:0
  s_waitcnt vmcnt(15)
  v_dot2_f32_bf16 v53, v64, v12, 0
  v_dot2_f32_bf16 v53, v65, v13, v53
  v_dot2_f32_bf16 v53, v66, v14, v53
  v_dot2_f32_bf16 v53, v67, v15, v53
  v_add_f32_dpp v55, v52, v52 row_ror:8 row_mask:0xf bank_mask:0x3
  s_nop 1
  v_add_f32_dpp v55, v53, v53 row_ror:8 row_mask:0xf bank_mask:0xc
  v_add_f32_dpp v56, v54, v54 row_shl:4 row_mask:0xf bank_mask:0x5
  s_nop 1
  v_add_f32_dpp v56, v55, v55 row_shr:4 row_mask:0xf bank_mask:0xa
  s_add_u32 s60, s59, 458752
  buffer_load_dwordx4 v[64:67], v1, s[8:11], s60 offen offset:2048 nt
  s_waitcnt vmcnt(15)
  v_dot2_f32_bf16 v52, v68, v12, 0
  v_dot2_f32_bf16 v52, v69, v13, v52
  v_dot2_f32_bf16 v52, v70, v14, v52
  v_dot2_f32_bf16 v52, v71, v15, v52
  s_add_u32 s60, s59, 458752
  buffer_load_dwordx4 v[68:71], v1, s[8:11], s60 offen offset:3072 nt
  s_waitcnt vmcnt(15)
  v_lshlrev_b32 v44, 16, v72
  v_and_b32 v45, v63, v72
  v_lshlrev_b32 v46, 16, v73
  v_and_b32 v47, v63, v73
  v_lshlrev_b32 v48, 16, v74
  v_and_b32 v49, v63, v74
  v_lshlrev_b32 v50, 16, v75
  v_and_b32 v51, v63, v75
  v_fmac_f32_dpp v28, v9, v44 row_newbcast:4 row_mask:0xf bank_mask:0xf
  v_fmac_f32_dpp v29, v9, v45 row_newbcast:4 row_mask:0xf bank_mask:0xf
  v_fmac_f32_dpp v30, v9, v46 row_newbcast:4 row_mask:0xf bank_mask:0xf
  v_fmac_f32_dpp v31, v9, v47 row_newbcast:4 row_mask:0xf bank_mask:0xf
  v_fmac_f32_dpp v32, v9, v48 row_newbcast:4 row_mask:0xf bank_mask:0xf
  v_fmac_f32_dpp v33, v9, v49 row_newbcast:4 row_mask:0xf bank_mask:0xf
  v_fmac_f32_dpp v34, v9, v50 row_newbcast:4 row_mask:0xf bank_mask:0xf
  v_fmac_f32_dpp v35, v9, v51 row_newbcast:4 row_mask:0xf bank_mask:0xf
  buffer_load_dwordx4 v[72:75], v4, s[20:23], s63 offen offset:0
  s_waitcnt vmcnt(15)
  v_dot2_f32_bf16 v53, v76, v12, 0
  v_dot2_f32_bf16 v53, v77, v13, v53
  v_dot2_f32_bf16 v53, v78, v14, v53
  v_dot2_f32_bf16 v53, v79, v15, v53
  v_add_f32_dpp v54, v52, v52 row_ror:8 row_mask:0xf bank_mask:0x3
  s_nop 1
  v_add_f32_dpp v54, v53, v53 row_ror:8 row_mask:0xf bank_mask:0xc
  s_add_u32 s60, s59, 262144
  buffer_load_dwordx4 v[76:79], v1, s[12:15], s60 offen offset:0 nt
  s_waitcnt vmcnt(15)
  v_dot2_f32_bf16 v52, v80, v12, 0
  v_dot2_f32_bf16 v52, v81, v13, v52
  v_dot2_f32_bf16 v52, v82, v14, v52
  v_dot2_f32_bf16 v52, v83, v15, v52
  s_add_u32 s60, s59, 262144
  buffer_load_dwordx4 v[80:83], v1, s[12:15], s60 offen offset:1024 nt
  s_waitcnt vmcnt(15)
  v_lshlrev_b32 v44, 16, v84
  v_and_b32 v45, v63, v84
  v_lshlrev_b32 v46, 16, v85
  v_and_b32 v47, v63, v85
  v_lshlrev_b32 v48, 16, v86
  v_and_b32 v49, v63, v86
  v_lshlrev_b32 v50, 16, v87
  v_and_b32 v51, v63, v87
  v_fmac_f32_dpp v28, v9, v44 row_newbcast:5 row_mask:0xf bank_mask:0xf
  v_fmac_f32_dpp v29, v9, v45 row_newbcast:5 row_mask:0xf bank_mask:0xf
  v_fmac_f32_dpp v30, v9, v46 row_newbcast:5 row_mask:0xf bank_mask:0xf
  v_fmac_f32_dpp v31, v9, v47 row_newbcast:5 row_mask:0xf bank_mask:0xf
  v_fmac_f32_dpp v32, v9, v48 row_newbcast:5 row_mask:0xf bank_mask:0xf
  v_fmac_f32_dpp v33, v9, v49 row_newbcast:5 row_mask:0xf bank_mask:0xf
  v_fmac_f32_dpp v34, v9, v50 row_newbcast:5 row_mask:0xf bank_mask:0xf
  v_fmac_f32_dpp v35, v9, v51 row_newbcast:5 row_mask:0xf bank_mask:0xf
  buffer_load_dwordx4 v[84:87], v5, s[20:23], s63 offen offset:0
  s_waitcnt vmcnt(15)
  v_dot2_f32_bf16 v53, v88, v12, 0
  v_dot2_f32_bf16 v53, v89, v13, v53
  v_dot2_f32_bf16 v53, v90, v14, v53
  v_dot2_f32_bf16 v53, v91, v15, v53
  v_add_f32_dpp v55, v52, v52 row_ror:8 row_mask:0xf bank_mask:0x3
  s_nop 1
  v_add_f32_dpp v55, v53, v53 row_ror:8 row_mask:0xf bank_mask:0xc
  v_add_f32_dpp v57, v54, v54 row_shl:4 row_mask:0xf bank_mask:0x5
  s_nop 1
  v_add_f32_dpp v57, v55, v55 row_shr:4 row_mask:0xf bank_mask:0xa
  v_add_f32_dpp v56, v56, v56 quad_perm:[2,3,0,1] row_mask:0xf bank_mask:0xf
  s_nop 0
  v_add_f32_dpp v57, v57, v57 quad_perm:[2,3,0,1] row_mask:0xf bank_mask:0xf
  v_cndmask_b32 v58, v56, v57, s[84:85]
  s_add_u32 s60, s59, 262144
  buffer_load_dwordx4 v[88:91], v1, s[12:15], s60 offen offset:2048 nt
  s_waitcnt vmcnt(15)
  v_dot2_f32_bf16 v52, v92, v12, 0
  v_dot2_f32_bf16 v52, v93, v13, v52
  v_dot2_f32_bf16 v52, v94, v14, v52
  v_dot2_f32_bf16 v52, v95, v15, v52
  s_add_u32 s60, s59, 262144
  buffer_load_dwordx4 v[92:95], v1, s[12:15], s60 offen offset:3072 nt
  s_waitcnt vmcnt(15)
  v_lshlrev_b32 v44, 16, v96
  v_and_b32 v45, v63, v96
  v_lshlrev_b32 v46, 16, v97
  v_and_b32 v47, v63, v97
  v_lshlrev_b32 v48, 16, v98
  v_and_b32 v49, v63, v98
  v_lshlrev_b32 v50, 16, v99
  v_and_b32 v51, v63, v99
  v_fmac_f32_dpp v28, v9, v44 row_newbcast:6 row_mask:0xf bank_mask:0xf
  v_fmac_f32_dpp v29, v9, v45 row_newbcast:6 row_mask:0xf bank_mask:0xf
  v_fmac_f32_dpp v30, v9, v46 row_newbcast:6 row_mask:0xf bank_mask:0xf
  v_fmac_f32_dpp v31, v9, v47 row_newbcast:6 row_mask:0xf bank_mask:0xf
  v_fmac_f32_dpp v32, v9, v48 row_newbcast:6 row_mask:0xf bank_mask:0xf
  v_fmac_f32_dpp v33, v9, v49 row_newbcast:6 row_mask:0xf bank_mask:0xf
  v_fmac_f32_dpp v34, v9, v50 row_newbcast:6 row_mask:0xf bank_mask:0xf
  v_fmac_f32_dpp v35, v9, v51 row_newbcast:6 row_mask:0xf bank_mask:0xf
  s_add_u32 s60, s59, 327680
  buffer_load_dwordx4 v[96:99], v1, s[12:15], s60 offen offset:0 nt
  s_waitcnt vmcnt(15)
  v_dot2_f32_bf16 v53, v100, v12, 0
  v_dot2_f32_bf16 v53, v101, v13, v53
  v_dot2_f32_bf16 v53, v102, v14, v53
  v_dot2_f32_bf16 v53, v103, v15, v53
  v_add_f32_dpp v54, v52, v52 row_ror:8 row_mask:0xf bank_mask:0x3
  s_nop 1
  v_add_f32_dpp v54, v53, v53 row_ror:8 row_mask:0xf bank_mask:0xc
  buffer_load_dwordx4 v[100:103], v4, s[24:27], s63 offen offset:0
  s_waitcnt vmcnt(15)
  v_dot2_f32_bf16 v52, v104, v12, 0
  v_dot2_f32_bf16 v52, v105, v13, v52
  v_dot2_f32_bf16 v52, v106, v14, v52
  v_dot2_f32_bf16 v52, v107, v15, v52
  s_add_u32 s60, s59, 327680
  buffer_load_dwordx4 v[104:107], v1, s[12:15], s60 offen offset:1024 nt
  s_waitcnt vmcnt(15)
  v_dot2_f32_bf16 v53, v108, v12, 0
  v_dot2_f32_bf16 v53, v109, v13, v53
  v_dot2_f32_bf16 v53, v110, v14, v53
  v_dot2_f32_bf16 v53, v111, v15, v53
  v_add_f32_dpp v55, v52, v52 row_ror:8 row_mask:0xf bank_mask:0x3
  s_nop 1
  v_add_f32_dpp v55, v53, v53 row_ror:8 row_mask:0xf bank_mask:0xc
  v_add_f32_dpp v56, v54, v54 row_shl:4 row_mask:0xf bank_mask:0x5
  s_nop 1
  v_add_f32_dpp v56, v55, v55 row_shr:4 row_mask:0xf bank_mask:0xa
  s_add_u32 s60, s59, 327680
  buffer_load_dwordx4 v[108:111], v1, s[12:15], s60 offen offset:2048 nt
  s_waitcnt vmcnt(15)
  v_lshlrev_b32 v44, 16, v112
  v_and_b32 v45, v63, v112
  v_lshlrev_b32 v46, 16, v113
  v_and_b32 v47, v63, v113
  v_lshlrev_b32 v48, 16, v114
  v_and_b32 v49, v63, v114
  v_lshlrev_b32 v50, 16, v115
  v_and_b32 v51, v63, v115
  v_fmac_f32_dpp v28, v9, v44 row_newbcast:7 row_mask:0xf bank_mask:0xf
  v_fmac_f32_dpp v29, v9, v45 row_newbcast:7 row_mask:0xf bank_mask:0xf
  v_fmac_f32_dpp v30, v9, v46 row_newbcast:7 row_mask:0xf bank_mask:0xf
  v_fmac_f32_dpp v31, v9, v47 row_newbcast:7 row_mask:0xf bank_mask:0xf
  v_fmac_f32_dpp v32, v9, v48 row_newbcast:7 row_mask:0xf bank_mask:0xf
  v_fmac_f32_dpp v33, v9, v49 row_newbcast:7 row_mask:0xf bank_mask:0xf
  v_fmac_f32_dpp v34, v9, v50 row_newbcast:7 row_mask:0xf bank_mask:0xf
  v_fmac_f32_dpp v35, v9, v51 row_newbcast:7 row_mask:0xf bank_mask:0xf
  buffer_load_dwordx4 v[112:115], v5, s[24:27], s63 offen offset:0
  s_waitcnt vmcnt(15)
  v_dot2_f32_bf16 v52, v116, v12, 0
  v_dot2_f32_bf16 v52, v117, v13, v52
  v_dot2_f32_bf16 v52, v118, v14, v52
  v_dot2_f32_bf16 v52, v119, v15, v52
  s_add_u32 s60, s59, 327680
  buffer_load_dwordx4 v[116:119], v1, s[12:15], s60 offen offset:3072 nt
  s_waitcnt vmcnt(15)
  v_dot2_f32_bf16 v53, v120, v12, 0
  v_dot2_f32_bf16 v53, v121, v13, v53
  v_dot2_f32_bf16 v53, v122, v14, v53
  v_dot2_f32_bf16 v53, v123, v15, v53
  v_add_f32_dpp v54, v52, v52 row_ror:8 row_mask:0xf bank_mask:0x3
  s_nop 1
  v_add_f32_dpp v54, v53, v53 row_ror:8 row_mask:0xf bank_mask:0xc
  s_add_u32 s60, s59, 393216
  buffer_load_dwordx4 v[120:123], v1, s[12:15], s60 offen offset:0 nt
  s_waitcnt vmcnt(15)
  v_lshlrev_b32 v44, 16, v124
  v_and_b32 v45, v63, v124
  v_lshlrev_b32 v46, 16, v125
  v_and_b32 v47, v63, v125
  v_lshlrev_b32 v48, 16, v126
  v_and_b32 v49, v63, v126
  v_lshlrev_b32 v50, 16, v127
  v_and_b32 v51, v63, v127
  v_fmac_f32_dpp v28, v9, v44 row_newbcast:8 row_mask:0xf bank_mask:0xf
  v_fmac_f32_dpp v29, v9, v45 row_newbcast:8 row_mask:0xf bank_mask:0xf
  v_fmac_f32_dpp v30, v9, v46 row_newbcast:8 row_mask:0xf bank_mask:0xf
  v_fmac_f32_dpp v31, v9, v47 row_newbcast:8 row_mask:0xf bank_mask:0xf
  v_fmac_f32_dpp v32, v9, v48 row_newbcast:8 row_mask:0xf bank_mask:0xf
  v_fmac_f32_dpp v33, v9, v49 row_newbcast:8 row_mask:0xf bank_mask:0xf
  v_fmac_f32_dpp v34, v9, v50 row_newbcast:8 row_mask:0xf bank_mask:0xf
  v_fmac_f32_dpp v35, v9, v51 row_newbcast:8 row_mask:0xf bank_mask:0xf
  buffer_load_dwordx4 v[124:127], v1, s[36:39], s66 offen offset:0
  v_permlane32_swap_b32 v28, v32
  v_permlane32_swap_b32 v29, v33
  v_permlane32_swap_b32 v30, v34
  v_permlane32_swap_b32 v31, v35
  v_add_f32 v28, v28, v32
  v_add_f32 v29, v29, v33
  v_add_f32 v30, v30, v34
  v_add_f32 v31, v31, v35
  s_nop 0
  v_permlane16_swap_b32 v28, v30
  v_permlane16_swap_b32 v29, v31
  v_add_f32 v28, v28, v30
  v_add_f32 v29, v29, v31
  ds_write_b64 v60, v[28:29] offset:16384
  s_waitcnt vmcnt(15)
  v_dot2_f32_bf16 v52, v64, v12, 0
  v_dot2_f32_bf16 v52, v65, v13, v52
  v_dot2_f32_bf16 v52, v66, v14, v52
  v_dot2_f32_bf16 v52, v67, v15, v52
  buffer_load_dwordx4 v[64:67], v1, s[40:43], 0 offen
  s_waitcnt vmcnt(15)
  v_dot2_f32_bf16 v53, v68, v12, 0
  v_dot2_f32_bf16 v53, v69, v13, v53
  v_dot2_f32_bf16 v53, v70, v14, v53
  v_dot2_f32_bf16 v53, v71, v15, v53
  v_add_f32_dpp v55, v52, v52 row_ror:8 row_mask:0xf bank_mask:0x3
  s_nop 1
  v_add_f32_dpp v55, v53, v53 row_ror:8 row_mask:0xf bank_mask:0xc
  v_add_f32_dpp v57, v54, v54 row_shl:4 row_mask:0xf bank_mask:0x5
  s_nop 1
  v_add_f32_dpp v57, v55, v55 row_shr:4 row_mask:0xf bank_mask:0xa
  v_add_f32_dpp v56, v56, v56 quad_perm:[2,3,0,1] row_mask:0xf bank_mask:0xf
  s_nop 0
  v_add_f32_dpp v57, v57, v57 quad_perm:[2,3,0,1] row_mask:0xf bank_mask:0xf
  v_cndmask_b32 v59, v56, v57, s[84:85]
  v_add_f32_dpp v58, v58, v58 quad_perm:[1,0,3,2] row_mask:0xf bank_mask:0xf
  s_nop 0
  v_add_f32_dpp v59, v59, v59 quad_perm:[1,0,3,2] row_mask:0xf bank_mask:0xf
  v_cndmask_b32 v52, v58, v59, s[86:87]
  s_add_u32 s60, s59, 393216
  buffer_load_dwordx4 v[68:71], v1, s[12:15], s60 offen offset:1024 nt
  v_cvt_pk_bf16_f32 v52, v52, v52
  v_lshlrev_b32 v52, 16, v52
  v_mul_f32 v52, 0x3db504f3, v52
  v_cvt_pk_bf16_f32 v52, v52, v52
  v_lshlrev_b32 v52, 16, v52
  v_mul_f32 v52, 0x3fb8aa3b, v52
  v_mov_b32 v53, v52
  s_nop 1
  v_max_f32_dpp v53, v53, v53 quad_perm:[1,0,3,2] row_mask:0xf bank_mask:0xf
  s_nop 1
  v_max_f32_dpp v53, v53, v53 quad_perm:[2,3,0,1] row_mask:0xf bank_mask:0xf
  s_nop 1
  v_max_f32_dpp v53, v53, v53 row_half_mirror row_mask:0xf bank_mask:0xf
  s_nop 1
  v_max_f32_dpp v53, v53, v53 row_ror:8 row_mask:0xf bank_mask:0xf
  v_max_f32 v53, v53, v24
  v_sub_f32 v54, v24, v53
  v_sub_f32 v26, v52, v53
  v_exp_f32 v54, v54
  v_exp_f32 v26, v26
  v_mov_b32 v24, v53
  v_fma_f32 v25, v25, v54, v26
  v_mul_f32 v16, v16, v54
  v_mul_f32 v17, v17, v54
  v_mul_f32 v18, v18, v54
  v_mul_f32 v19, v19, v54
  v_mul_f32 v20, v20, v54
  v_mul_f32 v21, v21, v54
  v_mul_f32 v22, v22, v54
  v_mul_f32 v23, v23, v54
  s_waitcnt vmcnt(15)
  v_lshlrev_b32 v44, 16, v72
  v_and_b32 v45, v63, v72
  v_lshlrev_b32 v46, 16, v73
  v_and_b32 v47, v63, v73
  v_lshlrev_b32 v48, 16, v74
  v_and_b32 v49, v63, v74
  v_lshlrev_b32 v50, 16, v75
  v_and_b32 v51, v63, v75
  v_mul_f32 v28, v10, v44
  v_mul_f32 v29, v10, v45
  v_mul_f32 v30, v10, v46
  v_mul_f32 v31, v10, v47
  v_mul_f32 v32, v10, v48
  v_mul_f32 v33, v10, v49
  v_mul_f32 v34, v10, v50
  v_mul_f32 v35, v10, v51
  s_add_u32 s60, s59, 393216
  buffer_load_dwordx4 v[72:75], v1, s[12:15], s60 offen offset:2048 nt
  s_waitcnt vmcnt(15)
  v_lshlrev_b32 v44, 16, v76
  v_and_b32 v45, v63, v76
  v_lshlrev_b32 v46, 16, v77
  v_and_b32 v47, v63, v77
  v_lshlrev_b32 v48, 16, v78
  v_and_b32 v49, v63, v78
  v_lshlrev_b32 v50, 16, v79
  v_and_b32 v51, v63, v79
  v_fmac_f32_dpp v16, v26, v44 row_newbcast:0 row_mask:0xf bank_mask:0xf
  v_fmac_f32_dpp v17, v26, v45 row_newbcast:0 row_mask:0xf bank_mask:0xf
  v_fmac_f32_dpp v18, v26, v46 row_newbcast:0 row_mask:0xf bank_mask:0xf
  v_fmac_f32_dpp v19, v26, v47 row_newbcast:0 row_mask:0xf bank_mask:0xf
  v_fmac_f32_dpp v20, v26, v48 row_newbcast:0 row_mask:0xf bank_mask:0xf
  v_fmac_f32_dpp v21, v26, v49 row_newbcast:0 row_mask:0xf bank_mask:0xf
  v_fmac_f32_dpp v22, v26, v50 row_newbcast:0 row_mask:0xf bank_mask:0xf
  v_fmac_f32_dpp v23, v26, v51 row_newbcast:0 row_mask:0xf bank_mask:0xf
  buffer_load_dwordx4 v[76:79], v7, s[36:39], s66 offen offset:0
  s_waitcnt vmcnt(15)
  v_lshlrev_b32 v44, 16, v80
  v_and_b32 v45, v63, v80
  v_lshlrev_b32 v46, 16, v81
  v_and_b32 v47, v63, v81
  v_lshlrev_b32 v48, 16, v82
  v_and_b32 v49, v63, v82
  v_lshlrev_b32 v50, 16, v83
  v_and_b32 v51, v63, v83
  v_fmac_f32_dpp v16, v26, v44 row_newbcast:8 row_mask:0xf bank_mask:0xf
  v_fmac_f32_dpp v17, v26, v45 row_newbcast:8 row_mask:0xf bank_mask:0xf
  v_fmac_f32_dpp v18, v26, v46 row_newbcast:8 row_mask:0xf bank_mask:0xf
  v_fmac_f32_dpp v19, v26, v47 row_newbcast:8 row_mask:0xf bank_mask:0xf
  v_fmac_f32_dpp v20, v26, v48 row_newbcast:8 row_mask:0xf bank_mask:0xf
  v_fmac_f32_dpp v21, v26, v49 row_newbcast:8 row_mask:0xf bank_mask:0xf
  v_fmac_f32_dpp v22, v26, v50 row_newbcast:8 row_mask:0xf bank_mask:0xf
  v_fmac_f32_dpp v23, v26, v51 row_newbcast:8 row_mask:0xf bank_mask:0xf
  buffer_load_dwordx4 v[80:83], v7, s[40:43], 0 offen
  s_waitcnt vmcnt(15)
  v_lshlrev_b32 v44, 16, v84
  v_and_b32 v45, v63, v84
  v_lshlrev_b32 v46, 16, v85
  v_and_b32 v47, v63, v85
  v_lshlrev_b32 v48, 16, v86
  v_and_b32 v49, v63, v86
  v_lshlrev_b32 v50, 16, v87
  v_and_b32 v51, v63, v87
  v_fmac_f32 v28, v11, v44
  v_fmac_f32 v29, v11, v45
  v_fmac_f32 v30, v11, v46
  v_fmac_f32 v31, v11, v47
  v_fmac_f32 v32, v11, v48
  v_fmac_f32 v33, v11, v49
  v_fmac_f32 v34, v11, v50
  v_fmac_f32 v35, v11, v51
  s_add_u32 s60, s59, 393216
  buffer_load_dwordx4 v[84:87], v1, s[12:15], s60 offen offset:3072 nt
  v_permlane32_swap_b32 v28, v32
  v_permlane32_swap_b32 v29, v33
  v_permlane32_swap_b32 v30, v34
  v_permlane32_swap_b32 v31, v35
  v_add_f32 v28, v28, v32
  v_add_f32 v29, v29, v33
  v_add_f32 v30, v30, v34
  v_add_f32 v31, v31, v35
  s_nop 0
  v_permlane16_swap_b32 v28, v30
  v_permlane16_swap_b32 v29, v31
  v_add_f32 v28, v28, v30
  v_add_f32 v29, v29, v31
  ds_write_b64 v60, v[28:29] offset:24576
  s_waitcnt vmcnt(15)
  v_lshlrev_b32 v44, 16, v88
  v_and_b32 v45, v63, v88
  v_lshlrev_b32 v46, 16, v89
  v_and_b32 v47, v63, v89
  v_lshlrev_b32 v48, 16, v90
  v_and_b32 v49, v63, v90
  v_lshlrev_b32 v50, 16, v91
  v_and_b32 v51, v63, v91
  v_fmac_f32_dpp v16, v26, v44 row_newbcast:4 row_mask:0xf bank_mask:0xf
  v_fmac_f32_dpp v17, v26, v45 row_newbcast:4 row_mask:0xf bank_mask:0xf
  v_fmac_f32_dpp v18, v26, v46 row_newbcast:4 row_mask:0xf bank_mask:0xf
  v_fmac_f32_dpp v19, v26, v47 row_newbcast:4 row_mask:0xf bank_mask:0xf
  v_fmac_f32_dpp v20, v26, v48 row_newbcast:4 row_mask:0xf bank_mask:0xf
  v_fmac_f32_dpp v21, v26, v49 row_newbcast:4 row_mask:0xf bank_mask:0xf
  v_fmac_f32_dpp v22, v26, v50 row_newbcast:4 row_mask:0xf bank_mask:0xf
  v_fmac_f32_dpp v23, v26, v51 row_newbcast:4 row_mask:0xf bank_mask:0xf
  s_add_u32 s60, s59, 458752
  buffer_load_dwordx4 v[88:91], v1, s[12:15], s60 offen offset:0 nt
  s_waitcnt vmcnt(15)
  v_lshlrev_b32 v44, 16, v92
  v_and_b32 v45, v63, v92
  v_lshlrev_b32 v46, 16, v93
  v_and_b32 v47, v63, v93
  v_lshlrev_b32 v48, 16, v94
  v_and_b32 v49, v63, v94
  v_lshlrev_b32 v50, 16, v95
  v_and_b32 v51, v63, v95
  v_fmac_f32_dpp v16, v26, v44 row_newbcast:12 row_mask:0xf bank_mask:0xf
  v_fmac_f32_dpp v17, v26, v45 row_newbcast:12 row_mask:0xf bank_mask:0xf
  v_fmac_f32_dpp v18, v26, v46 row_newbcast:12 row_mask:0xf bank_mask:0xf
  v_fmac_f32_dpp v19, v26, v47 row_newbcast:12 row_mask:0xf bank_mask:0xf
  v_fmac_f32_dpp v20, v26, v48 row_newbcast:12 row_mask:0xf bank_mask:0xf
  v_fmac_f32_dpp v21, v26, v49 row_newbcast:12 row_mask:0xf bank_mask:0xf
  v_fmac_f32_dpp v22, v26, v50 row_newbcast:12 row_mask:0xf bank_mask:0xf
  v_fmac_f32_dpp v23, v26, v51 row_newbcast:12 row_mask:0xf bank_mask:0xf
  s_add_u32 s60, s59, 458752
  buffer_load_dwordx4 v[92:95], v1, s[12:15], s60 offen offset:1024 nt
  s_waitcnt vmcnt(15)
  v_lshlrev_b32 v44, 16, v96
  v_and_b32 v45, v63, v96
  v_lshlrev_b32 v46, 16, v97
  v_and_b32 v47, v63, v97
  v_lshlrev_b32 v48, 16, v98
  v_and_b32 v49, v63, v98
  v_lshlrev_b32 v50, 16, v99
  v_and_b32 v51, v63, v99
  v_fmac_f32_dpp v16, v26, v44 row_newbcast:2 row_mask:0xf bank_mask:0xf
  v_fmac_f32_dpp v17, v26, v45 row_newbcast:2 row_mask:0xf bank_mask:0xf
  v_fmac_f32_dpp v18, v26, v46 row_newbcast:2 row_mask:0xf bank_mask:0xf
  v_fmac_f32_dpp v19, v26, v47 row_newbcast:2 row_mask:0xf bank_mask:0xf
  v_fmac_f32_dpp v20, v26, v48 row_newbcast:2 row_mask:0xf bank_mask:0xf
  v_fmac_f32_dpp v21, v26, v49 row_newbcast:2 row_mask:0xf bank_mask:0xf
  v_fmac_f32_dpp v22, v26, v50 row_newbcast:2 row_mask:0xf bank_mask:0xf
  v_fmac_f32_dpp v23, v26, v51 row_newbcast:2 row_mask:0xf bank_mask:0xf
  s_add_u32 s60, s59, 458752
  buffer_load_dwordx4 v[96:99], v1, s[12:15], s60 offen offset:2048 nt
  s_waitcnt vmcnt(15)
  v_lshlrev_b32 v44, 16, v100
  v_and_b32 v45, v63, v100
  v_lshlrev_b32 v46, 16, v101
  v_and_b32 v47, v63, v101
  v_lshlrev_b32 v48, 16, v102
  v_and_b32 v49, v63, v102
  v_lshlrev_b32 v50, 16, v103
  v_and_b32 v51, v63, v103
  v_mul_f32 v28, v10, v44
  v_mul_f32 v29, v10, v45
  v_mul_f32 v30, v10, v46
  v_mul_f32 v31, v10, v47
  v_mul_f32 v32, v10, v48
  v_mul_f32 v33, v10, v49
  v_mul_f32 v34, v10, v50
  v_mul_f32 v35, v10, v51
  s_add_u32 s60, s59, 458752
  buffer_load_dwordx4 v[100:103], v1, s[12:15], s60 offen offset:3072 nt
  s_waitcnt vmcnt(15)
  v_lshlrev_b32 v44, 16, v104
  v_and_b32 v45, v63, v104
  v_lshlrev_b32 v46, 16, v105
  v_and_b32 v47, v63, v105
  v_lshlrev_b32 v48, 16, v106
  v_and_b32 v49, v63, v106
  v_lshlrev_b32 v50, 16, v107
  v_and_b32 v51, v63, v107
  v_fmac_f32_dpp v16, v26, v44 row_newbcast:10 row_mask:0xf bank_mask:0xf
  v_fmac_f32_dpp v17, v26, v45 row_newbcast:10 row_mask:0xf bank_mask:0xf
  v_fmac_f32_dpp v18, v26, v46 row_newbcast:10 row_mask:0xf bank_mask:0xf
  v_fmac_f32_dpp v19, v26, v47 row_newbcast:10 row_mask:0xf bank_mask:0xf
  v_fmac_f32_dpp v20, v26, v48 row_newbcast:10 row_mask:0xf bank_mask:0xf
  v_fmac_f32_dpp v21, v26, v49 row_newbcast:10 row_mask:0xf bank_mask:0xf
  v_fmac_f32_dpp v22, v26, v50 row_newbcast:10 row_mask:0xf bank_mask:0xf
  v_fmac_f32_dpp v23, v26, v51 row_newbcast:10 row_mask:0xf bank_mask:0xf
  buffer_load_dwordx4 v[104:107], v1, s[28:31], s64 offen offset:0
  s_waitcnt vmcnt(15)
  v_lshlrev_b32 v44, 16, v108
  v_and_b32 v45, v63, v108
  v_lshlrev_b32 v46, 16, v109
  v_and_b32 v47, v63, v109
  v_lshlrev_b32 v48, 16, v110
  v_and_b32 v49, v63, v110
  v_lshlrev_b32 v50, 16, v111
  v_and_b32 v51, v63, v111
  v_fmac_f32_dpp v16, v26, v44 row_newbcast:6 row_mask:0xf bank_mask:0xf
  v_fmac_f32_dpp v17, v26, v45 row_newbcast:6 row_mask:0xf bank_mask:0xf
  v_fmac_f32_dpp v18, v26, v46 row_newbcast:6 row_mask:0xf bank_mask:0xf
  v_fmac_f32_dpp v19, v26, v47 row_newbcast:6 row_mask:0xf bank_mask:0xf
  v_fmac_f32_dpp v20, v26, v48 row_newbcast:6 row_mask:0xf bank_mask:0xf
  v_fmac_f32_dpp v21, v26, v49 row_newbcast:6 row_mask:0xf bank_mask:0xf
  v_fmac_f32_dpp v22, v26, v50 row_newbcast:6 row_mask:0xf bank_mask:0xf
  v_fmac_f32_dpp v23, v26, v51 row_newbcast:6 row_mask:0xf bank_mask:0xf
  s_add_u32 s60, s59, 524288
  buffer_load_dwordx4 v[108:111], v1, s[8:11], s60 offen offset:0 nt
  s_waitcnt vmcnt(15)
  v_lshlrev_b32 v44, 16, v112
  v_and_b32 v45, v63, v112
  v_lshlrev_b32 v46, 16, v113
  v_and_b32 v47, v63, v113
  v_lshlrev_b32 v48, 16, v114
  v_and_b32 v49, v63, v114
  v_lshlrev_b32 v50, 16, v115
  v_and_b32 v51, v63, v115
  v_fmac_f32 v28, v11, v44
  v_fmac_f32 v29, v11, v45
  v_fmac_f32 v30, v11, v46
  v_fmac_f32 v31, v11, v47
  v_fmac_f32 v32, v11, v48
  v_fmac_f32 v33, v11, v49
  v_fmac_f32 v34, v11, v50
  v_fmac_f32 v35, v11, v51
  s_add_u32 s60, s59, 524288
  buffer_load_dwordx4 v[112:115], v1, s[8:11], s60 offen offset:1024 nt
  v_permlane32_swap_b32 v28, v32
  v_permlane32_swap_b32 v29, v33
  v_permlane32_swap_b32 v30, v34
  v_permlane32_swap_b32 v31, v35
  v_add_f32 v28, v28, v32
  v_add_f32 v29, v29, v33
  v_add_f32 v30, v30, v34
  v_add_f32 v31, v31, v35
  s_nop 0
  v_permlane16_swap_b32 v28, v30
  v_permlane16_swap_b32 v29, v31
  v_add_f32 v28, v28, v30
  v_add_f32 v29, v29, v31
  ds_write_b64 v60, v[28:29] offset:32768
  s_waitcnt vmcnt(15)
  v_lshlrev_b32 v44, 16, v116
  v_and_b32 v45, v63, v116
  v_lshlrev_b32 v46, 16, v117
  v_and_b32 v47, v63, v117
  v_lshlrev_b32 v48, 16, v118
  v_and_b32 v49, v63, v118
  v_lshlrev_b32 v50, 16, v119
  v_and_b32 v51, v63, v119
  v_fmac_f32_dpp v16, v26, v44 row_newbcast:14 row_mask:0xf bank_mask:0xf
  v_fmac_f32_dpp v17, v26, v45 row_newbcast:14 row_mask:0xf bank_mask:0xf
  v_fmac_f32_dpp v18, v26, v46 row_newbcast:14 row_mask:0xf bank_mask:0xf
  v_fmac_f32_dpp v19, v26, v47 row_newbcast:14 row_mask:0xf bank_mask:0xf
  v_fmac_f32_dpp v20, v26, v48 row_newbcast:14 row_mask:0xf bank_mask:0xf
  v_fmac_f32_dpp v21, v26, v49 row_newbcast:14 row_mask:0xf bank_mask:0xf
  v_fmac_f32_dpp v22, v26, v50 row_newbcast:14 row_mask:0xf bank_mask:0xf
  v_fmac_f32_dpp v23, v26, v51 row_newbcast:14 row_mask:0xf bank_mask:0xf
  s_add_u32 s60, s59, 524288
  buffer_load_dwordx4 v[116:119], v1, s[8:11], s60 offen offset:2048 nt
  s_waitcnt vmcnt(15)
  v_lshlrev_b32 v44, 16, v120
  v_and_b32 v45, v63, v120
  v_lshlrev_b32 v46, 16, v121
  v_and_b32 v47, v63, v121
  v_lshlrev_b32 v48, 16, v122
  v_and_b32 v49, v63, v122
  v_lshlrev_b32 v50, 16, v123
  v_and_b32 v51, v63, v123
  v_fmac_f32_dpp v16, v26, v44 row_newbcast:1 row_mask:0xf bank_mask:0xf
  v_fmac_f32_dpp v17, v26, v45 row_newbcast:1 row_mask:0xf bank_mask:0xf
  v_fmac_f32_dpp v18, v26, v46 row_newbcast:1 row_mask:0xf bank_mask:0xf
  v_fmac_f32_dpp v19, v26, v47 row_newbcast:1 row_mask:0xf bank_mask:0xf
  v_fmac_f32_dpp v20, v26, v48 row_newbcast:1 row_mask:0xf bank_mask:0xf
  v_fmac_f32_dpp v21, v26, v49 row_newbcast:1 row_mask:0xf bank_mask:0xf
  v_fmac_f32_dpp v22, v26, v50 row_newbcast:1 row_mask:0xf bank_mask:0xf
  v_fmac_f32_dpp v23, v26, v51 row_newbcast:1 row_mask:0xf bank_mask:0xf
  s_add_u32 s60, s59, 524288
  buffer_load_dwordx4 v[120:123], v1, s[8:11], s60 offen offset:3072 nt
  s_waitcnt vmcnt(15)
  s_waitcnt vmcnt(14)
  v_lshlrev_b32 v44, 16, v124
  v_lshlrev_b32 v45, 16, v64
  v_and_b32 v46, v63, v124
  v_and_b32 v47, v63, v64
  v_mul_f32 v44, v44, v45
  v_mul_f32 v46, v46, v47
  v_cvt_pk_bf16_f32 v44, v44, v46
  v_lshlrev_b32 v45, 16, v44
  v_and_b32 v46, v63, v44
  v_add_f32 v62, v45, v46
  v_lshlrev_b32 v44, 16, v125
  v_lshlrev_b32 v45, 16, v65
  v_and_b32 v46, v63, v125
  v_and_b32 v47, v63, v65
  v_mul_f32 v44, v44, v45
  v_mul_f32 v46, v46, v47
  v_cvt_pk_bf16_f32 v44, v44, v46
  v_lshlrev_b32 v45, 16, v44
  v_and_b32 v46, v63, v44
  v_add_f32 v62, v62, v45
  v_add_f32 v62, v62, v46
  v_lshlrev_b32 v44, 16, v126
  v_lshlrev_b32 v45, 16, v66
  v_and_b32 v46, v63, v126
  v_and_b32 v47, v63, v66
  v_mul_f32 v44, v44, v45
  v_mul_f32 v46, v46, v47
  v_cvt_pk_bf16_f32 v44, v44, v46
  v_lshlrev_b32 v45, 16, v44
  v_and_b32 v46, v63, v44
  v_add_f32 v62, v62, v45
  v_add_f32 v62, v62, v46
  v_lshlrev_b32 v44, 16, v127
  v_lshlrev_b32 v45, 16, v67
  v_and_b32 v46, v63, v127
  v_and_b32 v47, v63, v67
  v_mul_f32 v44, v44, v45
  v_mul_f32 v46, v46, v47
  v_cvt_pk_bf16_f32 v44, v44, v46
  v_lshlrev_b32 v45, 16, v44
  v_and_b32 v46, v63, v44
  v_add_f32 v62, v62, v45
  v_add_f32 v62, v62, v46
  buffer_load_dwordx4 v[124:127], v1, s[28:31], s64 offen offset:1152
  s_add_u32 s60, s59, 589824
  buffer_load_dwordx4 v[64:67], v1, s[8:11], s60 offen offset:0 nt
  s_waitcnt vmcnt(15)
  v_lshlrev_b32 v44, 16, v68
  v_and_b32 v45, v63, v68
  v_lshlrev_b32 v46, 16, v69
  v_and_b32 v47, v63, v69
  v_lshlrev_b32 v48, 16, v70
  v_and_b32 v49, v63, v70
  v_lshlrev_b32 v50, 16, v71
  v_and_b32 v51, v63, v71
  v_fmac_f32_dpp v16, v26, v44 row_newbcast:9 row_mask:0xf bank_mask:0xf
  v_fmac_f32_dpp v17, v26, v45 row_newbcast:9 row_mask:0xf bank_mask:0xf
  v_fmac_f32_dpp v18, v26, v46 row_newbcast:9 row_mask:0xf bank_mask:0xf
  v_fmac_f32_dpp v19, v26, v47 row_newbcast:9 row_mask:0xf bank_mask:0xf
  v_fmac_f32_dpp v20, v26, v48 row_newbcast:9 row_mask:0xf bank_mask:0xf
  v_fmac_f32_dpp v21, v26, v49 row_newbcast:9 row_mask:0xf bank_mask:0xf
  v_fmac_f32_dpp v22, v26, v50 row_newbcast:9 row_mask:0xf bank_mask:0xf
  v_fmac_f32_dpp v23, v26, v51 row_newbcast:9 row_mask:0xf bank_mask:0xf
  s_add_u32 s60, s59, 589824
  buffer_load_dwordx4 v[68:71], v1, s[8:11], s60 offen offset:1024 nt
  s_waitcnt vmcnt(15)
  v_lshlrev_b32 v44, 16, v72
  v_and_b32 v45, v63, v72
  v_lshlrev_b32 v46, 16, v73
  v_and_b32 v47, v63, v73
  v_lshlrev_b32 v48, 16, v74
  v_and_b32 v49, v63, v74
  v_lshlrev_b32 v50, 16, v75
  v_and_b32 v51, v63, v75
  v_fmac_f32_dpp v16, v26, v44 row_newbcast:5 row_mask:0xf bank_mask:0xf
  v_fmac_f32_dpp v17, v26, v45 row_newbcast:5 row_mask:0xf bank_mask:0xf
  v_fmac_f32_dpp v18, v26, v46 row_newbcast:5 row_mask:0xf bank_mask:0xf
  v_fmac_f32_dpp v19, v26, v47 row_newbcast:5 row_mask:0xf bank_mask:0xf
  v_fmac_f32_dpp v20, v26, v48 row_newbcast:5 row_mask:0xf bank_mask:0xf
  v_fmac_f32_dpp v21, v26, v49 row_newbcast:5 row_mask:0xf bank_mask:0xf
  v_fmac_f32_dpp v22, v26, v50 row_newbcast:5 row_mask:0xf bank_mask:0xf
  v_fmac_f32_dpp v23, v26, v51 row_newbcast:5 row_mask:0xf bank_mask:0xf
  s_add_u32 s60, s59, 589824
  buffer_load_dwordx4 v[72:75], v1, s[8:11], s60 offen offset:2048 nt
  s_waitcnt vmcnt(15)
  s_waitcnt vmcnt(14)
  v_lshlrev_b32 v44, 16, v76
  v_lshlrev_b32 v45, 16, v80
  v_and_b32 v46, v63, v76
  v_and_b32 v47, v63, v80
  v_mul_f32 v44, v44, v45
  v_mul_f32 v46, v46, v47
  v_cvt_pk_bf16_f32 v44, v44, v46
  v_lshlrev_b32 v45, 16, v44
  v_and_b32 v46, v63, v44
  v_add_f32 v62, v62, v45
  v_add_f32 v62, v62, v46
  v_lshlrev_b32 v44, 16, v77
  v_lshlrev_b32 v45, 16, v81
  v_and_b32 v46, v63, v77
  v_and_b32 v47, v63, v81
  v_mul_f32 v44, v44, v45
  v_mul_f32 v46, v46, v47
  v_cvt_pk_bf16_f32 v44, v44, v46
  v_lshlrev_b32 v45, 16, v44
  v_and_b32 v46, v63, v44
  v_add_f32 v62, v62, v45
  v_add_f32 v62, v62, v46
  v_lshlrev_b32 v44, 16, v78
  v_lshlrev_b32 v45, 16, v82
  v_and_b32 v46, v63, v78
  v_and_b32 v47, v63, v82
  v_mul_f32 v44, v44, v45
  v_mul_f32 v46, v46, v47
  v_cvt_pk_bf16_f32 v44, v44, v46
  v_lshlrev_b32 v45, 16, v44
  v_and_b32 v46, v63, v44
  v_add_f32 v62, v62, v45
  v_add_f32 v62, v62, v46
  v_lshlrev_b32 v44, 16, v79
  v_lshlrev_b32 v45, 16, v83
  v_and_b32 v46, v63, v79
  v_and_b32 v47, v63, v83
  v_mul_f32 v44, v44, v45
  v_mul_f32 v46, v46, v47
  v_cvt_pk_bf16_f32 v44, v44, v46
  v_lshlrev_b32 v45, 16, v44
  v_and_b32 v46, v63, v44
  v_add_f32 v62, v62, v45
  v_add_f32 v62, v62, v46
  s_add_u32 s60, s59, 589824
  buffer_load_dwordx4 v[76:79], v1, s[8:11], s60 offen offset:3072 nt
  buffer_load_dwordx4 v[80:83], v1, s[28:31], s64 offen offset:2304
  v_add_f32_dpp v62, v62, v62 quad_perm:[1,0,3,2] row_mask:0xf bank_mask:0xf
  s_nop 1
  v_add_f32_dpp v62, v62, v62 quad_perm:[2,3,0,1] row_mask:0xf bank_mask:0xf
  s_nop 1
  v_add_f32_dpp v62, v62, v62 row_half_mirror row_mask:0xf bank_mask:0xf
  s_nop 1
  v_add_f32_dpp v62, v62, v62 row_ror:8 row_mask:0xf bank_mask:0xf
  s_nop 0
  v_readlane_b32 s69, v62, 0
  v_readlane_b32 s70, v62, 16
  v_readlane_b32 s71, v62, 32
  v_readlane_b32 s72, v62, 48
  v_mov_b32 v44, s69
  v_add_f32 v44, s70, v44
  v_add_f32 v44, s71, v44
  v_add_f32 v44, s72, v44
  v_cvt_pk_bf16_f32 v44, v44, v44
  v_lshlrev_b32 v44, 16, v44
  v_mul_f32 v44, 0xbfb8aa3b, v44
  v_exp_f32 v44, v44
  s_nop 0
  v_add_f32 v44, 1.0, v44
  v_rcp_f32 v44, v44
  s_nop 0
  v_cvt_pk_bf16_f32 v44, v44, v44
  v_lshlrev_b32 v44, 16, v44
  s_nop 0
  v_readfirstlane_b32 s67, v44
  s_waitcnt vmcnt(15)
  v_lshlrev_b32 v44, 16, v84
  v_and_b32 v45, v63, v84
  v_lshlrev_b32 v46, 16, v85
  v_and_b32 v47, v63, v85
  v_lshlrev_b32 v48, 16, v86
  v_and_b32 v49, v63, v86
  v_lshlrev_b32 v50, 16, v87
  v_and_b32 v51, v63, v87
  v_fmac_f32_dpp v16, v26, v44 row_newbcast:13 row_mask:0xf bank_mask:0xf
  v_fmac_f32_dpp v17, v26, v45 row_newbcast:13 row_mask:0xf bank_mask:0xf
  v_fmac_f32_dpp v18, v26, v46 row_newbcast:13 row_mask:0xf bank_mask:0xf
  v_fmac_f32_dpp v19, v26, v47 row_newbcast:13 row_mask:0xf bank_mask:0xf
  v_fmac_f32_dpp v20, v26, v48 row_newbcast:13 row_mask:0xf bank_mask:0xf
  v_fmac_f32_dpp v21, v26, v49 row_newbcast:13 row_mask:0xf bank_mask:0xf
  v_fmac_f32_dpp v22, v26, v50 row_newbcast:13 row_mask:0xf bank_mask:0xf
  v_fmac_f32_dpp v23, v26, v51 row_newbcast:13 row_mask:0xf bank_mask:0xf
  s_add_u32 s60, s59, 655360
  buffer_load_dwordx4 v[84:87], v1, s[8:11], s60 offen offset:0 nt
  s_waitcnt vmcnt(15)
  v_lshlrev_b32 v44, 16, v88
  v_and_b32 v45, v63, v88
  v_lshlrev_b32 v46, 16, v89
  v_and_b32 v47, v63, v89
  v_lshlrev_b32 v48, 16, v90
  v_and_b32 v49, v63, v90
  v_lshlrev_b32 v50, 16, v91
  v_and_b32 v51, v63, v91
  v_fmac_f32_dpp v16, v26, v44 row_newbcast:3 row_mask:0xf bank_mask:0xf
  v_fmac_f32_dpp v17, v26, v45 row_newbcast:3 row_mask:0xf bank_mask:0xf
  v_fmac_f32_dpp v18, v26, v46 row_newbcast:3 row_mask:0xf bank_mask:0xf
  v_fmac_f32_dpp v19, v26, v47 row_newbcast:3 row_mask:0xf bank_mask:0xf
  v_fmac_f32_dpp v20, v26, v48 row_newbcast:3 row_mask:0xf bank_mask:0xf
  v_fmac_f32_dpp v21, v26, v49 row_newbcast:3 row_mask:0xf bank_mask:0xf
  v_fmac_f32_dpp v22, v26, v50 row_newbcast:3 row_mask:0xf bank_mask:0xf
  v_fmac_f32_dpp v23, v26, v51 row_newbcast:3 row_mask:0xf bank_mask:0xf
  s_add_u32 s60, s59, 655360
  buffer_load_dwordx4 v[88:91], v1, s[8:11], s60 offen offset:1024 nt
  s_waitcnt vmcnt(15)
  v_lshlrev_b32 v44, 16, v92
  v_and_b32 v45, v63, v92
  v_lshlrev_b32 v46, 16, v93
  v_and_b32 v47, v63, v93
  v_lshlrev_b32 v48, 16, v94
  v_and_b32 v49, v63, v94
  v_lshlrev_b32 v50, 16, v95
  v_and_b32 v51, v63, v95
  v_fmac_f32_dpp v16, v26, v44 row_newbcast:11 row_mask:0xf bank_mask:0xf
  v_fmac_f32_dpp v17, v26, v45 row_newbcast:11 row_mask:0xf bank_mask:0xf
  v_fmac_f32_dpp v18, v26, v46 row_newbcast:11 row_mask:0xf bank_mask:0xf
  v_fmac_f32_dpp v19, v26, v47 row_newbcast:11 row_mask:0xf bank_mask:0xf
  v_fmac_f32_dpp v20, v26, v48 row_newbcast:11 row_mask:0xf bank_mask:0xf
  v_fmac_f32_dpp v21, v26, v49 row_newbcast:11 row_mask:0xf bank_mask:0xf
  v_fmac_f32_dpp v22, v26, v50 row_newbcast:11 row_mask:0xf bank_mask:0xf
  v_fmac_f32_dpp v23, v26, v51 row_newbcast:11 row_mask:0xf bank_mask:0xf
  s_add_u32 s60, s59, 655360
  buffer_load_dwordx4 v[92:95], v1, s[8:11], s60 offen offset:2048 nt
  s_waitcnt vmcnt(15)
  v_lshlrev_b32 v44, 16, v96
  v_and_b32 v45, v63, v96
  v_lshlrev_b32 v46, 16, v97
  v_and_b32 v47, v63, v97
  v_lshlrev_b32 v48, 16, v98
  v_and_b32 v49, v63, v98
  v_lshlrev_b32 v50, 16, v99
  v_and_b32 v51, v63, v99
  v_fmac_f32_dpp v16, v26, v44 row_newbcast:7 row_mask:0xf bank_mask:0xf
  v_fmac_f32_dpp v17, v26, v45 row_newbcast:7 row_mask:0xf bank_mask:0xf
  v_fmac_f32_dpp v18, v26, v46 row_newbcast:7 row_mask:0xf bank_mask:0xf
  v_fmac_f32_dpp v19, v26, v47 row_newbcast:7 row_mask:0xf bank_mask:0xf
  v_fmac_f32_dpp v20, v26, v48 row_newbcast:7 row_mask:0xf bank_mask:0xf
  v_fmac_f32_dpp v21, v26, v49 row_newbcast:7 row_mask:0xf bank_mask:0xf
  v_fmac_f32_dpp v22, v26, v50 row_newbcast:7 row_mask:0xf bank_mask:0xf
  v_fmac_f32_dpp v23, v26, v51 row_newbcast:7 row_mask:0xf bank_mask:0xf
  s_add_u32 s60, s59, 655360
  buffer_load_dwordx4 v[96:99], v1, s[8:11], s60 offen offset:3072 nt
  s_waitcnt vmcnt(15)
  v_lshlrev_b32 v44, 16, v100
  v_and_b32 v45, v63, v100
  v_lshlrev_b32 v46, 16, v101
  v_and_b32 v47, v63, v101
  v_lshlrev_b32 v48, 16, v102
  v_and_b32 v49, v63, v102
  v_lshlrev_b32 v50, 16, v103
  v_and_b32 v51, v63, v103
  v_fmac_f32_dpp v16, v26, v44 row_newbcast:15 row_mask:0xf bank_mask:0xf
  v_fmac_f32_dpp v17, v26, v45 row_newbcast:15 row_mask:0xf bank_mask:0xf
  v_fmac_f32_dpp v18, v26, v46 row_newbcast:15 row_mask:0xf bank_mask:0xf
  v_fmac_f32_dpp v19, v26, v47 row_newbcast:15 row_mask:0xf bank_mask:0xf
  v_fmac_f32_dpp v20, v26, v48 row_newbcast:15 row_mask:0xf bank_mask:0xf
  v_fmac_f32_dpp v21, v26, v49 row_newbcast:15 row_mask:0xf bank_mask:0xf
  v_fmac_f32_dpp v22, v26, v50 row_newbcast:15 row_mask:0xf bank_mask:0xf
  v_fmac_f32_dpp v23, v26, v51 row_newbcast:15 row_mask:0xf bank_mask:0xf
  buffer_load_dwordx4 v[100:103], v1, s[28:31], s64 offen offset:3456
  s_waitcnt lgkmcnt(0)
  s_barrier
  v_and_b32 v44, 63, v0
  v_and_b32 v45, 7, v44
  v_lshrrev_b32 v46, 3, v44
  v_lshlrev_b32 v45, 9, v45
  v_lshl_add_u32 v45, v46, 2, v45
  s_lshl_b32 s69, s56, 5
  v_add_u32 v45, s69, v45
  ds_read_b32 v28, v45 offset:8192
  ds_read_b32 v29, v45 offset:12288
  ds_read_b32 v30, v45 offset:16384
  ds_read_b32 v31, v45 offset:20480
  v_lshlrev_b32 v47, 6, v44
  s_lshl_b32 s69, s56, 2
  v_add_u32 v47, s69, v47
  ds_read_b32 v32, v47 offset:24576
  ds_read_b32 v33, v47 offset:28672
  ds_read_b32 v34, v47 offset:32768
  ds_read_b32 v35, v47 offset:36864
  s_waitcnt lgkmcnt(0)
  v_add_f32 v28, v28, v29
  v_add_f32 v30, v30, v31
  v_add_f32 v32, v32, v33
  v_add_f32 v34, v34, v35
  v_add_f32_dpp v28, v28, v28 quad_perm:[1,0,3,2] row_mask:0xf bank_mask:0xf
  s_nop 1
  v_add_f32_dpp v28, v28, v28 quad_perm:[2,3,0,1] row_mask:0xf bank_mask:0xf
  s_nop 1
  v_add_f32_dpp v28, v28, v28 row_half_mirror row_mask:0xf bank_mask:0xf
  v_add_f32_dpp v30, v30, v30 quad_perm:[1,0,3,2] row_mask:0xf bank_mask:0xf
  s_nop 1
  v_add_f32_dpp v30, v30, v30 quad_perm:[2,3,0,1] row_mask:0xf bank_mask:0xf
  s_nop 1
  v_add_f32_dpp v30, v30, v30 row_half_mirror row_mask:0xf bank_mask:0xf
  v_add_f32_dpp v32, v32, v32 quad_perm:[1,0,3,2] row_mask:0xf bank_mask:0xf
  s_nop 1
  v_add_f32_dpp v32, v32, v32 quad_perm:[2,3,0,1] row_mask:0xf bank_mask:0xf
  s_nop 1
  v_add_f32_dpp v32, v32, v32 row_half_mirror row_mask:0xf bank_mask:0xf
  s_nop 1
  v_add_f32_dpp v32, v32, v32 row_ror:8 row_mask:0xf bank_mask:0xf
  v_add_f32_dpp v34, v34, v34 quad_perm:[1,0,3,2] row_mask:0xf bank_mask:0xf
  s_nop 1
  v_add_f32_dpp v34, v34, v34 quad_perm:[2,3,0,1] row_mask:0xf bank_mask:0xf
  s_nop 1
  v_add_f32_dpp v34, v34, v34 row_half_mirror row_mask:0xf bank_mask:0xf
  s_nop 1
  v_add_f32_dpp v34, v34, v34 row_ror:8 row_mask:0xf bank_mask:0xf
  v_readlane_b32 s69, v32, 0
  v_readlane_b32 s70, v32, 16
  v_readlane_b32 s71, v32, 32
  v_readlane_b32 s72, v32, 48
  v_mov_b32 v33, s69
  v_add_f32 v33, s70, v33
  v_add_f32 v33, s71, v33
  v_add_f32 v33, s72, v33
  v_readlane_b32 s69, v34, 0
  v_readlane_b32 s70, v34, 16
  v_readlane_b32 s71, v34, 32
  v_readlane_b32 s72, v34, 48
  v_mov_b32 v35, s69
  v_add_f32 v35, s70, v35
  v_add_f32 v35, s71, v35
  v_add_f32 v35, s72, v35
  v_cvt_pk_bf16_f32 v28, v28, v28
  v_lshlrev_b32 v28, 16, v28
  v_cvt_pk_bf16_f32 v30, v30, v30
  v_lshlrev_b32 v30, 16, v30
  v_mul_f32 v50, v28, v28
  v_mul_f32 v50, v50, v28
  v_mov_b32 v51, 0x3d372713
  v_fma_f32 v50, v50, v51, v28
  v_mul_f32 v50, 0xc0135761, v50
  v_exp_f32 v50, v50
  s_nop 0
  v_add_f32 v50, 1.0, v50
  v_rcp_f32 v50, v50
  s_nop 0
  v_mul_f32 v50, v28, v50
  v_cvt_pk_bf16_f32 v50, v50, v50
  v_lshlrev_b32 v50, 16, v50
  v_mul_f32 v50, v50, v30
  v_cvt_pk_bf16_f32 v61, v50, v50
  v_lshlrev_b32 v61, 16, v61
  v_cvt_pk_bf16_f32 v33, v33, v33
  v_lshlrev_b32 v33, 16, v33
  v_cvt_pk_bf16_f32 v35, v35, v35
  v_lshlrev_b32 v35, 16, v35
  v_mul_f32 v50, v33, v33
  v_mul_f32 v50, v50, v33
  v_mov_b32 v51, 0x3d372713
  v_fma_f32 v50, v50, v51, v33
  v_mul_f32 v50, 0xc0135761, v50
  v_exp_f32 v50, v50
  s_nop 0
  v_add_f32 v50, 1.0, v50
  v_rcp_f32 v50, v50
  s_nop 0
  v_mul_f32 v50, v33, v50
  v_cvt_pk_bf16_f32 v50, v50, v50
  v_lshlrev_b32 v50, 16, v50
  v_mul_f32 v50, v50, v35
  v_cvt_pk_bf16_f32 v29, v50, v50
  v_lshlrev_b32 v29, 16, v29
  v_mov_b32 v44, s67
  v_sub_f32 v44, 1.0, v44
  v_cvt_pk_bf16_f32 v44, v44, v44
  v_lshlrev_b32 v44, 16, v44
  v_mul_f32 v61, v61, v44
  v_mul_f32 v29, v29, v44
  v_readlane_b32 s76, v61, 0
  v_readlane_b32 s77, v61, 8
  v_readlane_b32 s78, v61, 16
  v_readlane_b32 s79, v61, 24
  v_readlane_b32 s80, v61, 32
  v_readlane_b32 s81, v61, 40
  v_readlane_b32 s82, v61, 48
  v_readlane_b32 s83, v61, 56
  v_readfirstlane_b32 s68, v29
  s_waitcnt vmcnt(15)
  v_lshlrev_b32 v44, 16, v104
  v_and_b32 v45, v63, v104
  v_lshlrev_b32 v46, 16, v105
  v_and_b32 v47, v63, v105
  v_lshlrev_b32 v48, 16, v106
  v_and_b32 v49, v63, v106
  v_lshlrev_b32 v50, 16, v107
  v_and_b32 v51, v63, v107
  v_mul_f32 v28, s76, v44
  v_mul_f32 v29, s76, v45
  v_mul_f32 v30, s76, v46
  v_mul_f32 v31, s76, v47
  v_mul_f32 v32, s76, v48
  v_mul_f32 v33, s76, v49
  v_mul_f32 v34, s76, v50
  v_mul_f32 v35, s76, v51
  s_add_u32 s60, s59, 720896
  buffer_load_dwordx4 v[104:107], v1, s[8:11], s60 offen offset:0 nt
  s_waitcnt vmcnt(15)
  v_dot2_f32_bf16 v52, v108, v12, 0
  v_dot2_f32_bf16 v52, v109, v13, v52
  v_dot2_f32_bf16 v52, v110, v14, v52
  v_dot2_f32_bf16 v52, v111, v15, v52
  s_add_u32 s60, s59, 720896
  buffer_load_dwordx4 v[108:111], v1, s[8:11], s60 offen offset:1024 nt
  s_waitcnt vmcnt(15)
  v_dot2_f32_bf16 v53, v112, v12, 0
  v_dot2_f32_bf16 v53, v113, v13, v53
  v_dot2_f32_bf16 v53, v114, v14, v53
  v_dot2_f32_bf16 v53, v115, v15, v53
  v_add_f32_dpp v54, v52, v52 row_ror:8 row_mask:0xf bank_mask:0x3
  s_nop 1
  v_add_f32_dpp v54, v53, v53 row_ror:8 row_mask:0xf bank_mask:0xc
  s_add_u32 s60, s59, 720896
  buffer_load_dwordx4 v[112:115], v1, s[8:11], s60 offen offset:2048 nt
  s_waitcnt vmcnt(15)
  v_dot2_f32_bf16 v52, v116, v12, 0
  v_dot2_f32_bf16 v52, v117, v13, v52
  v_dot2_f32_bf16 v52, v118, v14, v52
  v_dot2_f32_bf16 v52, v119, v15, v52
  s_add_u32 s60, s59, 720896
  buffer_load_dwordx4 v[116:119], v1, s[8:11], s60 offen offset:3072 nt
  s_waitcnt vmcnt(15)
  v_dot2_f32_bf16 v53, v120, v12, 0
  v_dot2_f32_bf16 v53, v121, v13, v53
  v_dot2_f32_bf16 v53, v122, v14, v53
  v_dot2_f32_bf16 v53, v123, v15, v53
  v_add_f32_dpp v55, v52, v52 row_ror:8 row_mask:0xf bank_mask:0x3
  s_nop 1
  v_add_f32_dpp v55, v53, v53 row_ror:8 row_mask:0xf bank_mask:0xc
  v_add_f32_dpp v56, v54, v54 row_shl:4 row_mask:0xf bank_mask:0x5
  s_nop 1
  v_add_f32_dpp v56, v55, v55 row_shr:4 row_mask:0xf bank_mask:0xa
  s_add_u32 s60, s64, 4096
  buffer_load_dwordx4 v[120:123], v1, s[28:31], s60 offen offset:512
  s_waitcnt vmcnt(15)
  v_lshlrev_b32 v44, 16, v124
  v_and_b32 v45, v63, v124
  v_lshlrev_b32 v46, 16, v125
  v_and_b32 v47, v63, v125
  v_lshlrev_b32 v48, 16, v126
  v_and_b32 v49, v63, v126
  v_lshlrev_b32 v50, 16, v127
  v_and_b32 v51, v63, v127
  v_fmac_f32 v28, s77, v44
  v_fmac_f32 v29, s77, v45
  v_fmac_f32 v30, s77, v46
  v_fmac_f32 v31, s77, v47
  v_fmac_f32 v32, s77, v48
  v_fmac_f32 v33, s77, v49
  v_fmac_f32 v34, s77, v50
  v_fmac_f32 v35, s77, v51
  s_add_u32 s60, s59, 524288
  buffer_load_dwordx4 v[124:127], v1, s[12:15], s60 offen offset:0 nt
  s_waitcnt vmcnt(15)
  v_dot2_f32_bf16 v52, v64, v12, 0
  v_dot2_f32_bf16 v52, v65, v13, v52
  v_dot2_f32_bf16 v52, v66, v14, v52
  v_dot2_f32_bf16 v52, v67, v15, v52
  s_add_u32 s60, s59, 524288
  buffer_load_dwordx4 v[64:67], v1, s[12:15], s60 offen offset:1024 nt
  s_waitcnt vmcnt(15)
  v_dot2_f32_bf16 v53, v68, v12, 0
  v_dot2_f32_bf16 v53, v69, v13, v53
  v_dot2_f32_bf16 v53, v70, v14, v53
  v_dot2_f32_bf16 v53, v71, v15, v53
  v_add_f32_dpp v54, v52, v52 row_ror:8 row_mask:0xf bank_mask:0x3
  s_nop 1
  v_add_f32_dpp v54, v53, v53 row_ror:8 row_mask:0xf bank_mask:0xc
  s_add_u32 s60, s59, 524288
  buffer_load_dwordx4 v[68:71], v1, s[12:15], s60 offen offset:2048 nt
  s_waitcnt vmcnt(15)
  v_dot2_f32_bf16 v52, v72, v12, 0
  v_dot2_f32_bf16 v52, v73, v13, v52
  v_dot2_f32_bf16 v52, v74, v14, v52
  v_dot2_f32_bf16 v52, v75, v15, v52
  s_add_u32 s60, s59, 524288
  buffer_load_dwordx4 v[72:75], v1, s[12:15], s60 offen offset:3072 nt
  s_waitcnt vmcnt(15)
  v_dot2_f32_bf16 v53, v76, v12, 0
  v_dot2_f32_bf16 v53, v77, v13, v53
  v_dot2_f32_bf16 v53, v78, v14, v53
  v_dot2_f32_bf16 v53, v79, v15, v53
  v_add_f32_dpp v55, v52, v52 row_ror:8 row_mask:0xf bank_mask:0x3
  s_nop 1
  v_add_f32_dpp v55, v53, v53 row_ror:8 row_mask:0xf bank_mask:0xc
  v_add_f32_dpp v57, v54, v54 row_shl:4 row_mask:0xf bank_mask:0x5
  s_nop 1
  v_add_f32_dpp v57, v55, v55 row_shr:4 row_mask:0xf bank_mask:0xa
  v_add_f32_dpp v56, v56, v56 quad_perm:[2,3,0,1] row_mask:0xf bank_mask:0xf
  s_nop 0
  v_add_f32_dpp v57, v57, v57 quad_perm:[2,3,0,1] row_mask:0xf bank_mask:0xf
  v_cndmask_b32 v58, v56, v57, s[84:85]
  s_add_u32 s60, s64, 4096
  buffer_load_dwordx4 v[76:79], v1, s[28:31], s60 offen offset:1664
  s_waitcnt vmcnt(15)
  v_lshlrev_b32 v44, 16, v80
  v_and_b32 v45, v63, v80
  v_lshlrev_b32 v46, 16, v81
  v_and_b32 v47, v63, v81
  v_lshlrev_b32 v48, 16, v82
  v_and_b32 v49, v63, v82
  v_lshlrev_b32 v50, 16, v83
  v_and_b32 v51, v63, v83
  v_fmac_f32 v28, s78, v44
  v_fmac_f32 v29, s78, v45
  v_fmac_f32 v30, s78, v46
  v_fmac_f32 v31, s78, v47
  v_fmac_f32 v32, s78, v48
  v_fmac_f32 v33, s78, v49
  v_fmac_f32 v34, s78, v50
  v_fmac_f32 v35, s78, v51
  s_add_u32 s60, s59, 589824
  buffer_load_dwordx4 v[80:83], v1, s[12:15], s60 offen offset:0 nt
  s_waitcnt vmcnt(15)
  v_dot2_f32_bf16 v52, v84, v12, 0
  v_dot2_f32_bf16 v52, v85, v13, v52
  v_dot2_f32_bf16 v52, v86, v14, v52
  v_dot2_f32_bf16 v52, v87, v15, v52
  s_add_u32 s60, s59, 589824
  buffer_load_dwordx4 v[84:87], v1, s[12:15], s60 offen offset:1024 nt
  s_waitcnt vmcnt(15)
  v_dot2_f32_bf16 v53, v88, v12, 0
  v_dot2_f32_bf16 v53, v89, v13, v53
  v_dot2_f32_bf16 v53, v90, v14, v53
  v_dot2_f32_bf16 v53, v91, v15, v53
  v_add_f32_dpp v54, v52, v52 row_ror:8 row_mask:0xf bank_mask:0x3
  s_nop 1
  v_add_f32_dpp v54, v53, v53 row_ror:8 row_mask:0xf bank_mask:0xc
  s_add_u32 s60, s59, 589824
  buffer_load_dwordx4 v[88:91], v1, s[12:15], s60 offen offset:2048 nt
  s_waitcnt vmcnt(15)
  v_dot2_f32_bf16 v52, v92, v12, 0
  v_dot2_f32_bf16 v52, v93, v13, v52
  v_dot2_f32_bf16 v52, v94, v14, v52
  v_dot2_f32_bf16 v52, v95, v15, v52
  s_add_u32 s60, s59, 589824
  buffer_load_dwordx4 v[92:95], v1, s[12:15], s60 offen offset:3072 nt
  s_waitcnt vmcnt(15)
  v_dot2_f32_bf16 v53, v96, v12, 0
  v_dot2_f32_bf16 v53, v97, v13, v53
  v_dot2_f32_bf16 v53, v98, v14, v53
  v_dot2_f32_bf16 v53, v99, v15, v53
  v_add_f32_dpp v55, v52, v52 row_ror:8 row_mask:0xf bank_mask:0x3
  s_nop 1
  v_add_f32_dpp v55, v53, v53 row_ror:8 row_mask:0xf bank_mask:0xc
  v_add_f32_dpp v56, v54, v54 row_shl:4 row_mask:0xf bank_mask:0x5
  s_nop 1
  v_add_f32_dpp v56, v55, v55 row_shr:4 row_mask:0xf bank_mask:0xa
  s_add_u32 s60, s59, 655360
  buffer_load_dwordx4 v[96:99], v1, s[12:15], s60 offen offset:0 nt
  s_waitcnt vmcnt(15)
  v_lshlrev_b32 v44, 16, v100
  v_and_b32 v45, v63, v100
  v_lshlrev_b32 v46, 16, v101
  v_and_b32 v47, v63, v101
  v_lshlrev_b32 v48, 16, v102
  v_and_b32 v49, v63, v102
  v_lshlrev_b32 v50, 16, v103
  v_and_b32 v51, v63, v103
  v_fmac_f32 v28, s79, v44
  v_fmac_f32 v29, s79, v45
  v_fmac_f32 v30, s79, v46
  v_fmac_f32 v31, s79, v47
  v_fmac_f32 v32, s79, v48
  v_fmac_f32 v33, s79, v49
  v_fmac_f32 v34, s79, v50
  v_fmac_f32 v35, s79, v51
  s_add_u32 s60, s64, 4096
  buffer_load_dwordx4 v[100:103], v1, s[28:31], s60 offen offset:2816
  s_waitcnt vmcnt(15)
  v_dot2_f32_bf16 v52, v104, v12, 0
  v_dot2_f32_bf16 v52, v105, v13, v52
  v_dot2_f32_bf16 v52, v106, v14, v52
  v_dot2_f32_bf16 v52, v107, v15, v52
  s_add_u32 s60, s59, 655360
  buffer_load_dwordx4 v[104:107], v1, s[12:15], s60 offen offset:1024 nt
  s_waitcnt vmcnt(15)
  v_dot2_f32_bf16 v53, v108, v12, 0
  v_dot2_f32_bf16 v53, v109, v13, v53
  v_dot2_f32_bf16 v53, v110, v14, v53
  v_dot2_f32_bf16 v53, v111, v15, v53
  v_add_f32_dpp v54, v52, v52 row_ror:8 row_mask:0xf bank_mask:0x3
  s_nop 1
  v_add_f32_dpp v54, v53, v53 row_ror:8 row_mask:0xf bank_mask:0xc
  s_add_u32 s60, s59, 655360
  buffer_load_dwordx4 v[108:111], v1, s[12:15], s60 offen offset:2048 nt
  s_waitcnt vmcnt(15)
  v_dot2_f32_bf16 v52, v112, v12, 0
  v_dot2_f32_bf16 v52, v113, v13, v52
  v_dot2_f32_bf16 v52, v114, v14, v52
  v_dot2_f32_bf16 v52, v115, v15, v52
  s_add_u32 s60, s59, 655360
  buffer_load_dwordx4 v[112:115], v1, s[12:15], s60 offen offset:3072 nt
  s_waitcnt vmcnt(15)
  v_dot2_f32_bf16 v53, v116, v12, 0
  v_dot2_f32_bf16 v53, v117, v13, v53
  v_dot2_f32_bf16 v53, v118, v14, v53
  v_dot2_f32_bf16 v53, v119, v15, v53
  v_add_f32_dpp v55, v52, v52 row_ror:8 row_mask:0xf bank_mask:0x3
  s_nop 1
  v_add_f32_dpp v55, v53, v53 row_ror:8 row_mask:0xf bank_mask:0xc
  v_add_f32_dpp v57, v54, v54 row_shl:4 row_mask:0xf bank_mask:0x5
  s_nop 1
  v_add_f32_dpp v57, v55, v55 row_shr:4 row_mask:0xf bank_mask:0xa
  v_add_f32_dpp v56, v56, v56 quad_perm:[2,3,0,1] row_mask:0xf bank_mask:0xf
  s_nop 0
  v_add_f32_dpp v57, v57, v57 quad_perm:[2,3,0,1] row_mask:0xf bank_mask:0xf
  v_cndmask_b32 v59, v56, v57, s[84:85]
  v_add_f32_dpp v58, v58, v58 quad_perm:[1,0,3,2] row_mask:0xf bank_mask:0xf
  s_nop 0
  v_add_f32_dpp v59, v59, v59 quad_perm:[1,0,3,2] row_mask:0xf bank_mask:0xf
  v_cndmask_b32 v52, v58, v59, s[86:87]
  s_add_u32 s60, s59, 720896
  buffer_load_dwordx4 v[116:119], v1, s[12:15], s60 offen offset:0 nt
  v_cvt_pk_bf16_f32 v52, v52, v52
  v_lshlrev_b32 v52, 16, v52
  v_mul_f32 v52, 0x3db504f3, v52
  v_cvt_pk_bf16_f32 v52, v52, v52
  v_lshlrev_b32 v52, 16, v52
  v_mul_f32 v52, 0x3fb8aa3b, v52
  v_mov_b32 v53, v52
  s_nop 1
  v_max_f32_dpp v53, v53, v53 quad_perm:[1,0,3,2] row_mask:0xf bank_mask:0xf
  s_nop 1
  v_max_f32_dpp v53, v53, v53 quad_perm:[2,3,0,1] row_mask:0xf bank_mask:0xf
  s_nop 1
  v_max_f32_dpp v53, v53, v53 row_half_mirror row_mask:0xf bank_mask:0xf
  s_nop 1
  v_max_f32_dpp v53, v53, v53 row_ror:8 row_mask:0xf bank_mask:0xf
  v_max_f32 v53, v53, v24
  v_sub_f32 v54, v24, v53
  v_sub_f32 v26, v52, v53
  v_exp_f32 v54, v54
  v_exp_f32 v26, v26
  v_mov_b32 v24, v53
  v_fma_f32 v25, v25, v54, v26
  v_mul_f32 v16, v16, v54
  v_mul_f32 v17, v17, v54
  v_mul_f32 v18, v18, v54
  v_mul_f32 v19, v19, v54
  v_mul_f32 v20, v20, v54
  v_mul_f32 v21, v21, v54
  v_mul_f32 v22, v22, v54
  v_mul_f32 v23, v23, v54
  s_waitcnt vmcnt(15)
  v_lshlrev_b32 v44, 16, v120
  v_and_b32 v45, v63, v120
  v_lshlrev_b32 v46, 16, v121
  v_and_b32 v47, v63, v121
  v_lshlrev_b32 v48, 16, v122
  v_and_b32 v49, v63, v122
  v_lshlrev_b32 v50, 16, v123
  v_and_b32 v51, v63, v123
  v_fmac_f32 v28, s80, v44
  v_fmac_f32 v29, s80, v45
  v_fmac_f32 v30, s80, v46
  v_fmac_f32 v31, s80, v47
  v_fmac_f32 v32, s80, v48
  v_fmac_f32 v33, s80, v49
  v_fmac_f32 v34, s80, v50
  v_fmac_f32 v35, s80, v51
  s_add_u32 s60, s64, 4096
  buffer_load_dwordx4 v[120:123], v1, s[28:31], s60 offen offset:3968
  s_waitcnt vmcnt(15)
  v_lshlrev_b32 v44, 16, v124
  v_and_b32 v45, v63, v124
  v_lshlrev_b32 v46, 16, v125
  v_and_b32 v47, v63, v125
  v_lshlrev_b32 v48, 16, v126
  v_and_b32 v49, v63, v126
  v_lshlrev_b32 v50, 16, v127
  v_and_b32 v51, v63, v127
  v_fmac_f32_dpp v16, v26, v44 row_newbcast:0 row_mask:0xf bank_mask:0xf
  v_fmac_f32_dpp v17, v26, v45 row_newbcast:0 row_mask:0xf bank_mask:0xf
  v_fmac_f32_dpp v18, v26, v46 row_newbcast:0 row_mask:0xf bank_mask:0xf
  v_fmac_f32_dpp v19, v26, v47 row_newbcast:0 row_mask:0xf bank_mask:0xf
  v_fmac_f32_dpp v20, v26, v48 row_newbcast:0 row_mask:0xf bank_mask:0xf
  v_fmac_f32_dpp v21, v26, v49 row_newbcast:0 row_mask:0xf bank_mask:0xf
  v_fmac_f32_dpp v22, v26, v50 row_newbcast:0 row_mask:0xf bank_mask:0xf
  v_fmac_f32_dpp v23, v26, v51 row_newbcast:0 row_mask:0xf bank_mask:0xf
  s_add_u32 s60, s59, 720896
  buffer_load_dwordx4 v[124:127], v1, s[12:15], s60 offen offset:1024 nt
  s_waitcnt vmcnt(15)
  v_lshlrev_b32 v44, 16, v64
  v_and_b32 v45, v63, v64
  v_lshlrev_b32 v46, 16, v65
  v_and_b32 v47, v63, v65
  v_lshlrev_b32 v48, 16, v66
  v_and_b32 v49, v63, v66
  v_lshlrev_b32 v50, 16, v67
  v_and_b32 v51, v63, v67
  v_fmac_f32_dpp v16, v26, v44 row_newbcast:8 row_mask:0xf bank_mask:0xf
  v_fmac_f32_dpp v17, v26, v45 row_newbcast:8 row_mask:0xf bank_mask:0xf
  v_fmac_f32_dpp v18, v26, v46 row_newbcast:8 row_mask:0xf bank_mask:0xf
  v_fmac_f32_dpp v19, v26, v47 row_newbcast:8 row_mask:0xf bank_mask:0xf
  v_fmac_f32_dpp v20, v26, v48 row_newbcast:8 row_mask:0xf bank_mask:0xf
  v_fmac_f32_dpp v21, v26, v49 row_newbcast:8 row_mask:0xf bank_mask:0xf
  v_fmac_f32_dpp v22, v26, v50 row_newbcast:8 row_mask:0xf bank_mask:0xf
  v_fmac_f32_dpp v23, v26, v51 row_newbcast:8 row_mask:0xf bank_mask:0xf
  s_add_u32 s60, s59, 720896
  buffer_load_dwordx4 v[64:67], v1, s[12:15], s60 offen offset:2048 nt
  s_waitcnt vmcnt(15)
  v_lshlrev_b32 v44, 16, v68
  v_and_b32 v45, v63, v68
  v_lshlrev_b32 v46, 16, v69
  v_and_b32 v47, v63, v69
  v_lshlrev_b32 v48, 16, v70
  v_and_b32 v49, v63, v70
  v_lshlrev_b32 v50, 16, v71
  v_and_b32 v51, v63, v71
  v_fmac_f32_dpp v16, v26, v44 row_newbcast:4 row_mask:0xf bank_mask:0xf
  v_fmac_f32_dpp v17, v26, v45 row_newbcast:4 row_mask:0xf bank_mask:0xf
  v_fmac_f32_dpp v18, v26, v46 row_newbcast:4 row_mask:0xf bank_mask:0xf
  v_fmac_f32_dpp v19, v26, v47 row_newbcast:4 row_mask:0xf bank_mask:0xf
  v_fmac_f32_dpp v20, v26, v48 row_newbcast:4 row_mask:0xf bank_mask:0xf
  v_fmac_f32_dpp v21, v26, v49 row_newbcast:4 row_mask:0xf bank_mask:0xf
  v_fmac_f32_dpp v22, v26, v50 row_newbcast:4 row_mask:0xf bank_mask:0xf
  v_fmac_f32_dpp v23, v26, v51 row_newbcast:4 row_mask:0xf bank_mask:0xf
  s_add_u32 s60, s59, 720896
  buffer_load_dwordx4 v[68:71], v1, s[12:15], s60 offen offset:3072 nt
  s_waitcnt vmcnt(15)
  v_lshlrev_b32 v44, 16, v72
  v_and_b32 v45, v63, v72
  v_lshlrev_b32 v46, 16, v73
  v_and_b32 v47, v63, v73
  v_lshlrev_b32 v48, 16, v74
  v_and_b32 v49, v63, v74
  v_lshlrev_b32 v50, 16, v75
  v_and_b32 v51, v63, v75
  v_fmac_f32_dpp v16, v26, v44 row_newbcast:12 row_mask:0xf bank_mask:0xf
  v_fmac_f32_dpp v17, v26, v45 row_newbcast:12 row_mask:0xf bank_mask:0xf
  v_fmac_f32_dpp v18, v26, v46 row_newbcast:12 row_mask:0xf bank_mask:0xf
  v_fmac_f32_dpp v19, v26, v47 row_newbcast:12 row_mask:0xf bank_mask:0xf
  v_fmac_f32_dpp v20, v26, v48 row_newbcast:12 row_mask:0xf bank_mask:0xf
  v_fmac_f32_dpp v21, v26, v49 row_newbcast:12 row_mask:0xf bank_mask:0xf
  v_fmac_f32_dpp v22, v26, v50 row_newbcast:12 row_mask:0xf bank_mask:0xf
  v_fmac_f32_dpp v23, v26, v51 row_newbcast:12 row_mask:0xf bank_mask:0xf
  s_add_u32 s60, s59, 786432
  buffer_load_dwordx4 v[72:75], v1, s[8:11], s60 offen offset:0 nt
  s_waitcnt vmcnt(15)
  v_lshlrev_b32 v44, 16, v76
  v_and_b32 v45, v63, v76
  v_lshlrev_b32 v46, 16, v77
  v_and_b32 v47, v63, v77
  v_lshlrev_b32 v48, 16, v78
  v_and_b32 v49, v63, v78
  v_lshlrev_b32 v50, 16, v79
  v_and_b32 v51, v63, v79
  v_fmac_f32 v28, s81, v44
  v_fmac_f32 v29, s81, v45
  v_fmac_f32 v30, s81, v46
  v_fmac_f32 v31, s81, v47
  v_fmac_f32 v32, s81, v48
  v_fmac_f32 v33, s81, v49
  v_fmac_f32 v34, s81, v50
  v_fmac_f32 v35, s81, v51
  buffer_load_dwordx4 v[76:79], v1, s[28:31], s65 offen offset:0
  s_waitcnt vmcnt(15)
  v_lshlrev_b32 v44, 16, v80
  v_and_b32 v45, v63, v80
  v_lshlrev_b32 v46, 16, v81
  v_and_b32 v47, v63, v81
  v_lshlrev_b32 v48, 16, v82
  v_and_b32 v49, v63, v82
  v_lshlrev_b32 v50, 16, v83
  v_and_b32 v51, v63, v83
  v_fmac_f32_dpp v16, v26, v44 row_newbcast:2 row_mask:0xf bank_mask:0xf
  v_fmac_f32_dpp v17, v26, v45 row_newbcast:2 row_mask:0xf bank_mask:0xf
  v_fmac_f32_dpp v18, v26, v46 row_newbcast:2 row_mask:0xf bank_mask:0xf
  v_fmac_f32_dpp v19, v26, v47 row_newbcast:2 row_mask:0xf bank_mask:0xf
  v_fmac_f32_dpp v20, v26, v48 row_newbcast:2 row_mask:0xf bank_mask:0xf
  v_fmac_f32_dpp v21, v26, v49 row_newbcast:2 row_mask:0xf bank_mask:0xf
  v_fmac_f32_dpp v22, v26, v50 row_newbcast:2 row_mask:0xf bank_mask:0xf
  v_fmac_f32_dpp v23, v26, v51 row_newbcast:2 row_mask:0xf bank_mask:0xf
  s_add_u32 s60, s59, 786432
  buffer_load_dwordx4 v[80:83], v1, s[8:11], s60 offen offset:1024 nt
  s_waitcnt vmcnt(15)
  v_lshlrev_b32 v44, 16, v84
  v_and_b32 v45, v63, v84
  v_lshlrev_b32 v46, 16, v85
  v_and_b32 v47, v63, v85
  v_lshlrev_b32 v48, 16, v86
  v_and_b32 v49, v63, v86
  v_lshlrev_b32 v50, 16, v87
  v_and_b32 v51, v63, v87
  v_fmac_f32_dpp v16, v26, v44 row_newbcast:10 row_mask:0xf bank_mask:0xf
  v_fmac_f32_dpp v17, v26, v45 row_newbcast:10 row_mask:0xf bank_mask:0xf
  v_fmac_f32_dpp v18, v26, v46 row_newbcast:10 row_mask:0xf bank_mask:0xf
  v_fmac_f32_dpp v19, v26, v47 row_newbcast:10 row_mask:0xf bank_mask:0xf
  v_fmac_f32_dpp v20, v26, v48 row_newbcast:10 row_mask:0xf bank_mask:0xf
  v_fmac_f32_dpp v21, v26, v49 row_newbcast:10 row_mask:0xf bank_mask:0xf
  v_fmac_f32_dpp v22, v26, v50 row_newbcast:10 row_mask:0xf bank_mask:0xf
  v_fmac_f32_dpp v23, v26, v51 row_newbcast:10 row_mask:0xf bank_mask:0xf
  s_add_u32 s60, s59, 786432
  buffer_load_dwordx4 v[84:87], v1, s[8:11], s60 offen offset:2048 nt
  s_waitcnt vmcnt(15)
  v_lshlrev_b32 v44, 16, v88
  v_and_b32 v45, v63, v88
  v_lshlrev_b32 v46, 16, v89
  v_and_b32 v47, v63, v89
  v_lshlrev_b32 v48, 16, v90
  v_and_b32 v49, v63, v90
  v_lshlrev_b32 v50, 16, v91
  v_and_b32 v51, v63, v91
  v_fmac_f32_dpp v16, v26, v44 row_newbcast:6 row_mask:0xf bank_mask:0xf
  v_fmac_f32_dpp v17, v26, v45 row_newbcast:6 row_mask:0xf bank_mask:0xf
  v_fmac_f32_dpp v18, v26, v46 row_newbcast:6 row_mask:0xf bank_mask:0xf
  v_fmac_f32_dpp v19, v26, v47 row_newbcast:6 row_mask:0xf bank_mask:0xf
  v_fmac_f32_dpp v20, v26, v48 row_newbcast:6 row_mask:0xf bank_mask:0xf
  v_fmac_f32_dpp v21, v26, v49 row_newbcast:6 row_mask:0xf bank_mask:0xf
  v_fmac_f32_dpp v22, v26, v50 row_newbcast:6 row_mask:0xf bank_mask:0xf
  v_fmac_f32_dpp v23, v26, v51 row_newbcast:6 row_mask:0xf bank_mask:0xf
  s_add_u32 s60, s59, 786432
  buffer_load_dwordx4 v[88:91], v1, s[8:11], s60 offen offset:3072 nt
  s_waitcnt vmcnt(15)
  v_lshlrev_b32 v44, 16, v92
  v_and_b32 v45, v63, v92
  v_lshlrev_b32 v46, 16, v93
  v_and_b32 v47, v63, v93
  v_lshlrev_b32 v48, 16, v94
  v_and_b32 v49, v63, v94
  v_lshlrev_b32 v50, 16, v95
  v_and_b32 v51, v63, v95
  v_fmac_f32_dpp v16, v26, v44 row_newbcast:14 row_mask:0xf bank_mask:0xf
  v_fmac_f32_dpp v17, v26, v45 row_newbcast:14 row_mask:0xf bank_mask:0xf
  v_fmac_f32_dpp v18, v26, v46 row_newbcast:14 row_mask:0xf bank_mask:0xf
  v_fmac_f32_dpp v19, v26, v47 row_newbcast:14 row_mask:0xf bank_mask:0xf
  v_fmac_f32_dpp v20, v26, v48 row_newbcast:14 row_mask:0xf bank_mask:0xf
  v_fmac_f32_dpp v21, v26, v49 row_newbcast:14 row_mask:0xf bank_mask:0xf
  v_fmac_f32_dpp v22, v26, v50 row_newbcast:14 row_mask:0xf bank_mask:0xf
  v_fmac_f32_dpp v23, v26, v51 row_newbcast:14 row_mask:0xf bank_mask:0xf
  s_add_u32 s60, s59, 851968
  buffer_load_dwordx4 v[92:95], v1, s[8:11], s60 offen offset:0 nt
  s_waitcnt vmcnt(15)
  v_lshlrev_b32 v44, 16, v96
  v_and_b32 v45, v63, v96
  v_lshlrev_b32 v46, 16, v97
  v_and_b32 v47, v63, v97
  v_lshlrev_b32 v48, 16, v98
  v_and_b32 v49, v63, v98
  v_lshlrev_b32 v50, 16, v99
  v_and_b32 v51, v63, v99
  v_fmac_f32_dpp v16, v26, v44 row_newbcast:1 row_mask:0xf bank_mask:0xf
  v_fmac_f32_dpp v17, v26, v45 row_newbcast:1 row_mask:0xf bank_mask:0xf
  v_fmac_f32_dpp v18, v26, v46 row_newbcast:1 row_mask:0xf bank_mask:0xf
  v_fmac_f32_dpp v19, v26, v47 row_newbcast:1 row_mask:0xf bank_mask:0xf
  v_fmac_f32_dpp v20, v26, v48 row_newbcast:1 row_mask:0xf bank_mask:0xf
  v_fmac_f32_dpp v21, v26, v49 row_newbcast:1 row_mask:0xf bank_mask:0xf
  v_fmac_f32_dpp v22, v26, v50 row_newbcast:1 row_mask:0xf bank_mask:0xf
  v_fmac_f32_dpp v23, v26, v51 row_newbcast:1 row_mask:0xf bank_mask:0xf
  buffer_load_dwordx4 v[96:99], v6, s[28:31], s64 offen offset:0
  s_waitcnt vmcnt(15)
  v_lshlrev_b32 v44, 16, v100
  v_and_b32 v45, v63, v100
  v_lshlrev_b32 v46, 16, v101
  v_and_b32 v47, v63, v101
  v_lshlrev_b32 v48, 16, v102
  v_and_b32 v49, v63, v102
  v_lshlrev_b32 v50, 16, v103
  v_and_b32 v51, v63, v103
  v_fmac_f32 v28, s82, v44
  v_fmac_f32 v29, s82, v45
  v_fmac_f32 v30, s82, v46
  v_fmac_f32 v31, s82, v47
  v_fmac_f32 v32, s82, v48
  v_fmac_f32 v33, s82, v49
  v_fmac_f32 v34, s82, v50
  v_fmac_f32 v35, s82, v51
  s_add_u32 s60, s59, 851968
  buffer_load_dwordx4 v[100:103], v1, s[8:11], s60 offen offset:1024 nt
  s_waitcnt vmcnt(15)
  v_lshlrev_b32 v44, 16, v104
  v_and_b32 v45, v63, v104
  v_lshlrev_b32 v46, 16, v105
  v_and_b32 v47, v63, v105
  v_lshlrev_b32 v48, 16, v106
  v_and_b32 v49, v63, v106
  v_lshlrev_b32 v50, 16, v107
  v_and_b32 v51, v63, v107
  v_fmac_f32_dpp v16, v26, v44 row_newbcast:9 row_mask:0xf bank_mask:0xf
  v_fmac_f32_dpp v17, v26, v45 row_newbcast:9 row_mask:0xf bank_mask:0xf
  v_fmac_f32_dpp v18, v26, v46 row_newbcast:9 row_mask:0xf bank_mask:0xf
  v_fmac_f32_dpp v19, v26, v47 row_newbcast:9 row_mask:0xf bank_mask:0xf
  v_fmac_f32_dpp v20, v26, v48 row_newbcast:9 row_mask:0xf bank_mask:0xf
  v_fmac_f32_dpp v21, v26, v49 row_newbcast:9 row_mask:0xf bank_mask:0xf
  v_fmac_f32_dpp v22, v26, v50 row_newbcast:9 row_mask:0xf bank_mask:0xf
  v_fmac_f32_dpp v23, v26, v51 row_newbcast:9 row_mask:0xf bank_mask:0xf
  s_add_u32 s60, s59, 851968
  buffer_load_dwordx4 v[104:107], v1, s[8:11], s60 offen offset:2048 nt
  s_waitcnt vmcnt(15)
  v_lshlrev_b32 v44, 16, v108
  v_and_b32 v45, v63, v108
  v_lshlrev_b32 v46, 16, v109
  v_and_b32 v47, v63, v109
  v_lshlrev_b32 v48, 16, v110
  v_and_b32 v49, v63, v110
  v_lshlrev_b32 v50, 16, v111
  v_and_b32 v51, v63, v111
  v_fmac_f32_dpp v16, v26, v44 row_newbcast:5 row_mask:0xf bank_mask:0xf
  v_fmac_f32_dpp v17, v26, v45 row_newbcast:5 row_mask:0xf bank_mask:0xf
  v_fmac_f32_dpp v18, v26, v46 row_newbcast:5 row_mask:0xf bank_mask:0xf
  v_fmac_f32_dpp v19, v26, v47 row_newbcast:5 row_mask:0xf bank_mask:0xf
  v_fmac_f32_dpp v20, v26, v48 row_newbcast:5 row_mask:0xf bank_mask:0xf
  v_fmac_f32_dpp v21, v26, v49 row_newbcast:5 row_mask:0xf bank_mask:0xf
  v_fmac_f32_dpp v22, v26, v50 row_newbcast:5 row_mask:0xf bank_mask:0xf
  v_fmac_f32_dpp v23, v26, v51 row_newbcast:5 row_mask:0xf bank_mask:0xf
  s_add_u32 s60, s59, 851968
  buffer_load_dwordx4 v[108:111], v1, s[8:11], s60 offen offset:3072 nt
  s_waitcnt vmcnt(15)
  v_lshlrev_b32 v44, 16, v112
  v_and_b32 v45, v63, v112
  v_lshlrev_b32 v46, 16, v113
  v_and_b32 v47, v63, v113
  v_lshlrev_b32 v48, 16, v114
  v_and_b32 v49, v63, v114
  v_lshlrev_b32 v50, 16, v115
  v_and_b32 v51, v63, v115
  v_fmac_f32_dpp v16, v26, v44 row_newbcast:13 row_mask:0xf bank_mask:0xf
  v_fmac_f32_dpp v17, v26, v45 row_newbcast:13 row_mask:0xf bank_mask:0xf
  v_fmac_f32_dpp v18, v26, v46 row_newbcast:13 row_mask:0xf bank_mask:0xf
  v_fmac_f32_dpp v19, v26, v47 row_newbcast:13 row_mask:0xf bank_mask:0xf
  v_fmac_f32_dpp v20, v26, v48 row_newbcast:13 row_mask:0xf bank_mask:0xf
  v_fmac_f32_dpp v21, v26, v49 row_newbcast:13 row_mask:0xf bank_mask:0xf
  v_fmac_f32_dpp v22, v26, v50 row_newbcast:13 row_mask:0xf bank_mask:0xf
  v_fmac_f32_dpp v23, v26, v51 row_newbcast:13 row_mask:0xf bank_mask:0xf
  s_add_u32 s60, s59, 917504
  buffer_load_dwordx4 v[112:115], v1, s[8:11], s60 offen offset:0 nt
  s_waitcnt vmcnt(15)
  v_lshlrev_b32 v44, 16, v116
  v_and_b32 v45, v63, v116
  v_lshlrev_b32 v46, 16, v117
  v_and_b32 v47, v63, v117
  v_lshlrev_b32 v48, 16, v118
  v_and_b32 v49, v63, v118
  v_lshlrev_b32 v50, 16, v119
  v_and_b32 v51, v63, v119
  v_fmac_f32_dpp v16, v26, v44 row_newbcast:3 row_mask:0xf bank_mask:0xf
  v_fmac_f32_dpp v17, v26, v45 row_newbcast:3 row_mask:0xf bank_mask:0xf
  v_fmac_f32_dpp v18, v26, v46 row_newbcast:3 row_mask:0xf bank_mask:0xf
  v_fmac_f32_dpp v19, v26, v47 row_newbcast:3 row_mask:0xf bank_mask:0xf
  v_fmac_f32_dpp v20, v26, v48 row_newbcast:3 row_mask:0xf bank_mask:0xf
  v_fmac_f32_dpp v21, v26, v49 row_newbcast:3 row_mask:0xf bank_mask:0xf
  v_fmac_f32_dpp v22, v26, v50 row_newbcast:3 row_mask:0xf bank_mask:0xf
  v_fmac_f32_dpp v23, v26, v51 row_newbcast:3 row_mask:0xf bank_mask:0xf
  buffer_load_dwordx4 v[116:119], v7, s[28:31], s65 offen offset:0
  s_waitcnt vmcnt(15)
  v_lshlrev_b32 v44, 16, v120
  v_and_b32 v45, v63, v120
  v_lshlrev_b32 v46, 16, v121
  v_and_b32 v47, v63, v121
  v_lshlrev_b32 v48, 16, v122
  v_and_b32 v49, v63, v122
  v_lshlrev_b32 v50, 16, v123
  v_and_b32 v51, v63, v123
  v_fmac_f32 v28, s83, v44
  v_fmac_f32 v29, s83, v45
  v_fmac_f32 v30, s83, v46
  v_fmac_f32 v31, s83, v47
  v_fmac_f32 v32, s83, v48
  v_fmac_f32 v33, s83, v49
  v_fmac_f32 v34, s83, v50
  v_fmac_f32 v35, s83, v51
  s_add_u32 s60, s59, 917504
  buffer_load_dwordx4 v[120:123], v1, s[8:11], s60 offen offset:1024 nt
  s_waitcnt vmcnt(15)
  v_lshlrev_b32 v44, 16, v124
  v_and_b32 v45, v63, v124
  v_lshlrev_b32 v46, 16, v125
  v_and_b32 v47, v63, v125
  v_lshlrev_b32 v48, 16, v126
  v_and_b32 v49, v63, v126
  v_lshlrev_b32 v50, 16, v127
  v_and_b32 v51, v63, v127
  v_fmac_f32_dpp v16, v26, v44 row_newbcast:11 row_mask:0xf bank_mask:0xf
  v_fmac_f32_dpp v17, v26, v45 row_newbcast:11 row_mask:0xf bank_mask:0xf
  v_fmac_f32_dpp v18, v26, v46 row_newbcast:11 row_mask:0xf bank_mask:0xf
  v_fmac_f32_dpp v19, v26, v47 row_newbcast:11 row_mask:0xf bank_mask:0xf
  v_fmac_f32_dpp v20, v26, v48 row_newbcast:11 row_mask:0xf bank_mask:0xf
  v_fmac_f32_dpp v21, v26, v49 row_newbcast:11 row_mask:0xf bank_mask:0xf
  v_fmac_f32_dpp v22, v26, v50 row_newbcast:11 row_mask:0xf bank_mask:0xf
  v_fmac_f32_dpp v23, v26, v51 row_newbcast:11 row_mask:0xf bank_mask:0xf
  s_add_u32 s60, s59, 917504
  buffer_load_dwordx4 v[124:127], v1, s[8:11], s60 offen offset:2048 nt
  s_waitcnt vmcnt(15)
  v_lshlrev_b32 v44, 16, v64
  v_and_b32 v45, v63, v64
  v_lshlrev_b32 v46, 16, v65
  v_and_b32 v47, v63, v65
  v_lshlrev_b32 v48, 16, v66
  v_and_b32 v49, v63, v66
  v_lshlrev_b32 v50, 16, v67
  v_and_b32 v51, v63, v67
  v_fmac_f32_dpp v16, v26, v44 row_newbcast:7 row_mask:0xf bank_mask:0xf
  v_fmac_f32_dpp v17, v26, v45 row_newbcast:7 row_mask:0xf bank_mask:0xf
  v_fmac_f32_dpp v18, v26, v46 row_newbcast:7 row_mask:0xf bank_mask:0xf
  v_fmac_f32_dpp v19, v26, v47 row_newbcast:7 row_mask:0xf bank_mask:0xf
  v_fmac_f32_dpp v20, v26, v48 row_newbcast:7 row_mask:0xf bank_mask:0xf
  v_fmac_f32_dpp v21, v26, v49 row_newbcast:7 row_mask:0xf bank_mask:0xf
  v_fmac_f32_dpp v22, v26, v50 row_newbcast:7 row_mask:0xf bank_mask:0xf
  v_fmac_f32_dpp v23, v26, v51 row_newbcast:7 row_mask:0xf bank_mask:0xf
  s_add_u32 s60, s59, 917504
  buffer_load_dwordx4 v[64:67], v1, s[8:11], s60 offen offset:3072 nt
  s_waitcnt vmcnt(15)
  v_lshlrev_b32 v44, 16, v68
  v_and_b32 v45, v63, v68
  v_lshlrev_b32 v46, 16, v69
  v_and_b32 v47, v63, v69
  v_lshlrev_b32 v48, 16, v70
  v_and_b32 v49, v63, v70
  v_lshlrev_b32 v50, 16, v71
  v_and_b32 v51, v63, v71
  v_fmac_f32_dpp v16, v26, v44 row_newbcast:15 row_mask:0xf bank_mask:0xf
  v_fmac_f32_dpp v17, v26, v45 row_newbcast:15 row_mask:0xf bank_mask:0xf
  v_fmac_f32_dpp v18, v26, v46 row_newbcast:15 row_mask:0xf bank_mask:0xf
  v_fmac_f32_dpp v19, v26, v47 row_newbcast:15 row_mask:0xf bank_mask:0xf
  v_fmac_f32_dpp v20, v26, v48 row_newbcast:15 row_mask:0xf bank_mask:0xf
  v_fmac_f32_dpp v21, v26, v49 row_newbcast:15 row_mask:0xf bank_mask:0xf
  v_fmac_f32_dpp v22, v26, v50 row_newbcast:15 row_mask:0xf bank_mask:0xf
  v_fmac_f32_dpp v23, v26, v51 row_newbcast:15 row_mask:0xf bank_mask:0xf
  s_add_u32 s60, s59, 983040
  buffer_load_dwordx4 v[68:71], v1, s[8:11], s60 offen offset:0 nt
  s_waitcnt vmcnt(15)
  v_dot2_f32_bf16 v52, v72, v12, 0
  v_dot2_f32_bf16 v52, v73, v13, v52
  v_dot2_f32_bf16 v52, v74, v14, v52
  v_dot2_f32_bf16 v52, v75, v15, v52
  s_add_u32 s60, s59, 983040
  buffer_load_dwordx4 v[72:75], v1, s[8:11], s60 offen offset:1024 nt
  s_waitcnt vmcnt(15)
  v_lshlrev_b32 v44, 16, v76
  v_and_b32 v45, v63, v76
  v_lshlrev_b32 v46, 16, v77
  v_and_b32 v47, v63, v77
  v_lshlrev_b32 v48, 16, v78
  v_and_b32 v49, v63, v78
  v_lshlrev_b32 v50, 16, v79
  v_and_b32 v51, v63, v79
  v_fmac_f32 v28, s68, v44
  v_fmac_f32 v29, s68, v45
  v_fmac_f32 v30, s68, v46
  v_fmac_f32 v31, s68, v47
  v_fmac_f32 v32, s68, v48
  v_fmac_f32 v33, s68, v49
  v_fmac_f32 v34, s68, v50
  v_fmac_f32 v35, s68, v51
  s_add_u32 s60, s59, 983040
  buffer_load_dwordx4 v[76:79], v1, s[8:11], s60 offen offset:2048 nt
  s_waitcnt vmcnt(15)
  v_dot2_f32_bf16 v53, v80, v12, 0
  v_dot2_f32_bf16 v53, v81, v13, v53
  v_dot2_f32_bf16 v53, v82, v14, v53
  v_dot2_f32_bf16 v53, v83, v15, v53
  v_add_f32_dpp v54, v52, v52 row_ror:8 row_mask:0xf bank_mask:0x3
  s_nop 1
  v_add_f32_dpp v54, v53, v53 row_ror:8 row_mask:0xf bank_mask:0xc
  s_add_u32 s60, s59, 983040
  buffer_load_dwordx4 v[80:83], v1, s[8:11], s60 offen offset:3072 nt
  s_waitcnt vmcnt(15)
  v_dot2_f32_bf16 v52, v84, v12, 0
  v_dot2_f32_bf16 v52, v85, v13, v52
  v_dot2_f32_bf16 v52, v86, v14, v52
  v_dot2_f32_bf16 v52, v87, v15, v52
  s_add_u32 s60, s59, 786432
  buffer_load_dwordx4 v[84:87], v1, s[12:15], s60 offen offset:0 nt
  s_waitcnt vmcnt(15)
  v_dot2_f32_bf16 v53, v88, v12, 0
  v_dot2_f32_bf16 v53, v89, v13, v53
  v_dot2_f32_bf16 v53, v90, v14, v53
  v_dot2_f32_bf16 v53, v91, v15, v53
  v_add_f32_dpp v55, v52, v52 row_ror:8 row_mask:0xf bank_mask:0x3
  s_nop 1
  v_add_f32_dpp v55, v53, v53 row_ror:8 row_mask:0xf bank_mask:0xc
  v_add_f32_dpp v56, v54, v54 row_shl:4 row_mask:0xf bank_mask:0x5
  s_nop 1
  v_add_f32_dpp v56, v55, v55 row_shr:4 row_mask:0xf bank_mask:0xa
  s_add_u32 s60, s59, 786432
  buffer_load_dwordx4 v[88:91], v1, s[12:15], s60 offen offset:1024 nt
  s_waitcnt vmcnt(15)
  v_dot2_f32_bf16 v52, v92, v12, 0
  v_dot2_f32_bf16 v52, v93, v13, v52
  v_dot2_f32_bf16 v52, v94, v14, v52
  v_dot2_f32_bf16 v52, v95, v15, v52
  s_add_u32 s60, s59, 786432
  buffer_load_dwordx4 v[92:95], v1, s[12:15], s60 offen offset:2048 nt
  s_waitcnt vmcnt(15)
  v_lshlrev_b32 v44, 16, v96
  v_and_b32 v45, v63, v96
  v_lshlrev_b32 v46, 16, v97
  v_and_b32 v47, v63, v97
  v_lshlrev_b32 v48, 16, v98
  v_and_b32 v49, v63, v98
  v_lshlrev_b32 v50, 16, v99
  v_and_b32 v51, v63, v99
  v_mul_f32 v36, v61, v44
  v_mul_f32 v37, v61, v45
  v_mul_f32 v38, v61, v46
  v_mul_f32 v39, v61, v47
  v_mul_f32 v40, v61, v48
  v_mul_f32 v41, v61, v49
  v_mul_f32 v42, v61, v50
  v_mul_f32 v43, v61, v51
  s_add_u32 s60, s59, 786432
  buffer_load_dwordx4 v[96:99], v1, s[12:15], s60 offen offset:3072 nt
  s_waitcnt vmcnt(15)
  v_dot2_f32_bf16 v53, v100, v12, 0
  v_dot2_f32_bf16 v53, v101, v13, v53
  v_dot2_f32_bf16 v53, v102, v14, v53
  v_dot2_f32_bf16 v53, v103, v15, v53
  v_add_f32_dpp v54, v52, v52 row_ror:8 row_mask:0xf bank_mask:0x3
  s_nop 1
  v_add_f32_dpp v54, v53, v53 row_ror:8 row_mask:0xf bank_mask:0xc
  s_add_u32 s60, s59, 851968
  buffer_load_dwordx4 v[100:103], v1, s[12:15], s60 offen offset:0 nt
  s_waitcnt vmcnt(15)
  v_dot2_f32_bf16 v52, v104, v12, 0
  v_dot2_f32_bf16 v52, v105, v13, v52
  v_dot2_f32_bf16 v52, v106, v14, v52
  v_dot2_f32_bf16 v52, v107, v15, v52
  s_add_u32 s60, s59, 851968
  buffer_load_dwordx4 v[104:107], v1, s[12:15], s60 offen offset:1024 nt
  s_waitcnt vmcnt(15)
  v_dot2_f32_bf16 v53, v108, v12, 0
  v_dot2_f32_bf16 v53, v109, v13, v53
  v_dot2_f32_bf16 v53, v110, v14, v53
  v_dot2_f32_bf16 v53, v111, v15, v53
  v_add_f32_dpp v55, v52, v52 row_ror:8 row_mask:0xf bank_mask:0x3
  s_nop 1
  v_add_f32_dpp v55, v53, v53 row_ror:8 row_mask:0xf bank_mask:0xc
  v_add_f32_dpp v57, v54, v54 row_shl:4 row_mask:0xf bank_mask:0x5
  s_nop 1
  v_add_f32_dpp v57, v55, v55 row_shr:4 row_mask:0xf bank_mask:0xa
  v_add_f32_dpp v56, v56, v56 quad_perm:[2,3,0,1] row_mask:0xf bank_mask:0xf
  s_nop 0
  v_add_f32_dpp v57, v57, v57 quad_perm:[2,3,0,1] row_mask:0xf bank_mask:0xf
  v_cndmask_b32 v58, v56, v57, s[84:85]
  s_add_u32 s60, s59, 851968
  buffer_load_dwordx4 v[108:111], v1, s[12:15], s60 offen offset:2048 nt
  s_waitcnt vmcnt(15)
  v_dot2_f32_bf16 v52, v112, v12, 0
  v_dot2_f32_bf16 v52, v113, v13, v52
  v_dot2_f32_bf16 v52, v114, v14, v52
  v_dot2_f32_bf16 v52, v115, v15, v52
  s_add_u32 s60, s59, 851968
  buffer_load_dwordx4 v[112:115], v1, s[12:15], s60 offen offset:3072 nt
  s_waitcnt vmcnt(15)
  v_lshlrev_b32 v44, 16, v116
  v_and_b32 v45, v63, v116
  v_lshlrev_b32 v46, 16, v117
  v_and_b32 v47, v63, v117
  v_lshlrev_b32 v48, 16, v118
  v_and_b32 v49, v63, v118
  v_lshlrev_b32 v50, 16, v119
  v_and_b32 v51, v63, v119
  v_fmac_f32 v36, s68, v44
  v_fmac_f32 v37, s68, v45
  v_fmac_f32 v38, s68, v46
  v_fmac_f32 v39, s68, v47
  v_fmac_f32 v40, s68, v48
  v_fmac_f32 v41, s68, v49
  v_fmac_f32 v42, s68, v50
  v_fmac_f32 v43, s68, v51
  s_add_u32 s60, s59, 917504
  buffer_load_dwordx4 v[116:119], v1, s[12:15], s60 offen offset:0 nt
  s_waitcnt vmcnt(15)
  v_dot2_f32_bf16 v53, v120, v12, 0
  v_dot2_f32_bf16 v53, v121, v13, v53
  v_dot2_f32_bf16 v53, v122, v14, v53
  v_dot2_f32_bf16 v53, v123, v15, v53
  v_add_f32_dpp v54, v52, v52 row_ror:8 row_mask:0xf bank_mask:0x3
  s_nop 1
  v_add_f32_dpp v54, v53, v53 row_ror:8 row_mask:0xf bank_mask:0xc
  s_add_u32 s60, s59, 917504
  buffer_load_dwordx4 v[120:123], v1, s[12:15], s60 offen offset:1024 nt
  s_waitcnt vmcnt(15)
  v_dot2_f32_bf16 v52, v124, v12, 0
  v_dot2_f32_bf16 v52, v125, v13, v52
  v_dot2_f32_bf16 v52, v126, v14, v52
  v_dot2_f32_bf16 v52, v127, v15, v52
  s_add_u32 s60, s59, 917504
  buffer_load_dwordx4 v[124:127], v1, s[12:15], s60 offen offset:2048 nt
  s_waitcnt vmcnt(15)
  v_dot2_f32_bf16 v53, v64, v12, 0
  v_dot2_f32_bf16 v53, v65, v13, v53
  v_dot2_f32_bf16 v53, v66, v14, v53
  v_dot2_f32_bf16 v53, v67, v15, v53
  v_add_f32_dpp v55, v52, v52 row_ror:8 row_mask:0xf bank_mask:0x3
  s_nop 1
  v_add_f32_dpp v55, v53, v53 row_ror:8 row_mask:0xf bank_mask:0xc
  v_add_f32_dpp v56, v54, v54 row_shl:4 row_mask:0xf bank_mask:0x5
  s_nop 1
  v_add_f32_dpp v56, v55, v55 row_shr:4 row_mask:0xf bank_mask:0xa
  s_add_u32 s60, s59, 917504
  buffer_load_dwordx4 v[64:67], v1, s[12:15], s60 offen offset:3072 nt
  s_waitcnt vmcnt(15)
  v_dot2_f32_bf16 v52, v68, v12, 0
  v_dot2_f32_bf16 v52, v69, v13, v52
  v_dot2_f32_bf16 v52, v70, v14, v52
  v_dot2_f32_bf16 v52, v71, v15, v52
  s_add_u32 s60, s59, 983040
  buffer_load_dwordx4 v[68:71], v1, s[12:15], s60 offen offset:0 nt
  s_waitcnt vmcnt(15)
  v_dot2_f32_bf16 v53, v72, v12, 0
  v_dot2_f32_bf16 v53, v73, v13, v53
  v_dot2_f32_bf16 v53, v74, v14, v53
  v_dot2_f32_bf16 v53, v75, v15, v53
  v_add_f32_dpp v54, v52, v52 row_ror:8 row_mask:0xf bank_mask:0x3
  s_nop 1
  v_add_f32_dpp v54, v53, v53 row_ror:8 row_mask:0xf bank_mask:0xc
  s_add_u32 s60, s59, 983040
  buffer_load_dwordx4 v[72:75], v1, s[12:15], s60 offen offset:1024 nt
  s_waitcnt vmcnt(15)
  v_dot2_f32_bf16 v52, v76, v12, 0
  v_dot2_f32_bf16 v52, v77, v13, v52
  v_dot2_f32_bf16 v52, v78, v14, v52
  v_dot2_f32_bf16 v52, v79, v15, v52
  s_add_u32 s60, s59, 983040
  buffer_load_dwordx4 v[76:79], v1, s[12:15], s60 offen offset:2048 nt
  s_waitcnt vmcnt(15)
  v_dot2_f32_bf16 v53, v80, v12, 0
  v_dot2_f32_bf16 v53, v81, v13, v53
  v_dot2_f32_bf16 v53, v82, v14, v53
  v_dot2_f32_bf16 v53, v83, v15, v53
  v_add_f32_dpp v55, v52, v52 row_ror:8 row_mask:0xf bank_mask:0x3
  s_nop 1
  v_add_f32_dpp v55, v53, v53 row_ror:8 row_mask:0xf bank_mask:0xc
  v_add_f32_dpp v57, v54, v54 row_shl:4 row_mask:0xf bank_mask:0x5
  s_nop 1
  v_add_f32_dpp v57, v55, v55 row_shr:4 row_mask:0xf bank_mask:0xa
  v_add_f32_dpp v56, v56, v56 quad_perm:[2,3,0,1] row_mask:0xf bank_mask:0xf
  s_nop 0
  v_add_f32_dpp v57, v57, v57 quad_perm:[2,3,0,1] row_mask:0xf bank_mask:0xf
  v_cndmask_b32 v59, v56, v57, s[84:85]
  v_add_f32_dpp v58, v58, v58 quad_perm:[1,0,3,2] row_mask:0xf bank_mask:0xf
  s_nop 0
  v_add_f32_dpp v59, v59, v59 quad_perm:[1,0,3,2] row_mask:0xf bank_mask:0xf
  v_cndmask_b32 v52, v58, v59, s[86:87]
  s_add_u32 s60, s59, 983040
  buffer_load_dwordx4 v[80:83], v1, s[12:15], s60 offen offset:3072 nt
  v_cvt_pk_bf16_f32 v52, v52, v52
  v_lshlrev_b32 v52, 16, v52
  v_mul_f32 v52, 0x3db504f3, v52
  v_cvt_pk_bf16_f32 v52, v52, v52
  v_lshlrev_b32 v52, 16, v52
  v_mul_f32 v52, 0x3fb8aa3b, v52
  v_mov_b32 v53, v52
  s_nop 1
  v_max_f32_dpp v53, v53, v53 quad_perm:[1,0,3,2] row_mask:0xf bank_mask:0xf
  s_nop 1
  v_max_f32_dpp v53, v53, v53 quad_perm:[2,3,0,1] row_mask:0xf bank_mask:0xf
  s_nop 1
  v_max_f32_dpp v53, v53, v53 row_half_mirror row_mask:0xf bank_mask:0xf
  s_nop 1
  v_max_f32_dpp v53, v53, v53 row_ror:8 row_mask:0xf bank_mask:0xf
  v_max_f32 v53, v53, v24
  v_sub_f32 v54, v24, v53
  v_sub_f32 v26, v52, v53
  v_exp_f32 v54, v54
  v_exp_f32 v26, v26
  v_mov_b32 v24, v53
  v_fma_f32 v25, v25, v54, v26
  v_mul_f32 v16, v16, v54
  v_mul_f32 v17, v17, v54
  v_mul_f32 v18, v18, v54
  v_mul_f32 v19, v19, v54
  v_mul_f32 v20, v20, v54
  v_mul_f32 v21, v21, v54
  v_mul_f32 v22, v22, v54
  v_mul_f32 v23, v23, v54
  buffer_load_dwordx4 v[52:55], v6, s[32:35], s73 offen offset:0
  s_add_u32 s60, s73, 8192
  buffer_load_dwordx4 v[56:59], v6, s[32:35], s60 offen offset:1024
  s_waitcnt vmcnt(17)
  v_lshlrev_b32 v44, 16, v84
  v_and_b32 v45, v63, v84
  v_lshlrev_b32 v46, 16, v85
  v_and_b32 v47, v63, v85
  v_lshlrev_b32 v48, 16, v86
  v_and_b32 v49, v63, v86
  v_lshlrev_b32 v50, 16, v87
  v_and_b32 v51, v63, v87
  v_fmac_f32_dpp v16, v26, v44 row_newbcast:0 row_mask:0xf bank_mask:0xf
  v_fmac_f32_dpp v17, v26, v45 row_newbcast:0 row_mask:0xf bank_mask:0xf
  v_fmac_f32_dpp v18, v26, v46 row_newbcast:0 row_mask:0xf bank_mask:0xf
  v_fmac_f32_dpp v19, v26, v47 row_newbcast:0 row_mask:0xf bank_mask:0xf
  v_fmac_f32_dpp v20, v26, v48 row_newbcast:0 row_mask:0xf bank_mask:0xf
  v_fmac_f32_dpp v21, v26, v49 row_newbcast:0 row_mask:0xf bank_mask:0xf
  v_fmac_f32_dpp v22, v26, v50 row_newbcast:0 row_mask:0xf bank_mask:0xf
  v_fmac_f32_dpp v23, v26, v51 row_newbcast:0 row_mask:0xf bank_mask:0xf
  buffer_load_dwordx4 v[84:87], v1, s[32:35], s73 offen offset:0
  s_waitcnt vmcnt(17)
  v_lshlrev_b32 v44, 16, v88
  v_and_b32 v45, v63, v88
  v_lshlrev_b32 v46, 16, v89
  v_and_b32 v47, v63, v89
  v_lshlrev_b32 v48, 16, v90
  v_and_b32 v49, v63, v90
  v_lshlrev_b32 v50, 16, v91
  v_and_b32 v51, v63, v91
  v_fmac_f32_dpp v16, v26, v44 row_newbcast:8 row_mask:0xf bank_mask:0xf
  v_fmac_f32_dpp v17, v26, v45 row_newbcast:8 row_mask:0xf bank_mask:0xf
  v_fmac_f32_dpp v18, v26, v46 row_newbcast:8 row_mask:0xf bank_mask:0xf
  v_fmac_f32_dpp v19, v26, v47 row_newbcast:8 row_mask:0xf bank_mask:0xf
  v_fmac_f32_dpp v20, v26, v48 row_newbcast:8 row_mask:0xf bank_mask:0xf
  v_fmac_f32_dpp v21, v26, v49 row_newbcast:8 row_mask:0xf bank_mask:0xf
  v_fmac_f32_dpp v22, v26, v50 row_newbcast:8 row_mask:0xf bank_mask:0xf
  v_fmac_f32_dpp v23, v26, v51 row_newbcast:8 row_mask:0xf bank_mask:0xf
  buffer_load_dwordx4 v[88:91], v1, s[32:35], s73 offen offset:1152
  s_waitcnt vmcnt(17)
  v_lshlrev_b32 v44, 16, v92
  v_and_b32 v45, v63, v92
  v_lshlrev_b32 v46, 16, v93
  v_and_b32 v47, v63, v93
  v_lshlrev_b32 v48, 16, v94
  v_and_b32 v49, v63, v94
  v_lshlrev_b32 v50, 16, v95
  v_and_b32 v51, v63, v95
  v_fmac_f32_dpp v16, v26, v44 row_newbcast:4 row_mask:0xf bank_mask:0xf
  v_fmac_f32_dpp v17, v26, v45 row_newbcast:4 row_mask:0xf bank_mask:0xf
  v_fmac_f32_dpp v18, v26, v46 row_newbcast:4 row_mask:0xf bank_mask:0xf
  v_fmac_f32_dpp v19, v26, v47 row_newbcast:4 row_mask:0xf bank_mask:0xf
  v_fmac_f32_dpp v20, v26, v48 row_newbcast:4 row_mask:0xf bank_mask:0xf
  v_fmac_f32_dpp v21, v26, v49 row_newbcast:4 row_mask:0xf bank_mask:0xf
  v_fmac_f32_dpp v22, v26, v50 row_newbcast:4 row_mask:0xf bank_mask:0xf
  v_fmac_f32_dpp v23, v26, v51 row_newbcast:4 row_mask:0xf bank_mask:0xf
  buffer_load_dwordx4 v[92:95], v1, s[32:35], s73 offen offset:2304
  s_waitcnt vmcnt(17)
  v_lshlrev_b32 v44, 16, v96
  v_and_b32 v45, v63, v96
  v_lshlrev_b32 v46, 16, v97
  v_and_b32 v47, v63, v97
  v_lshlrev_b32 v48, 16, v98
  v_and_b32 v49, v63, v98
  v_lshlrev_b32 v50, 16, v99
  v_and_b32 v51, v63, v99
  v_fmac_f32_dpp v16, v26, v44 row_newbcast:12 row_mask:0xf bank_mask:0xf
  v_fmac_f32_dpp v17, v26, v45 row_newbcast:12 row_mask:0xf bank_mask:0xf
  v_fmac_f32_dpp v18, v26, v46 row_newbcast:12 row_mask:0xf bank_mask:0xf
  v_fmac_f32_dpp v19, v26, v47 row_newbcast:12 row_mask:0xf bank_mask:0xf
  v_fmac_f32_dpp v20, v26, v48 row_newbcast:12 row_mask:0xf bank_mask:0xf
  v_fmac_f32_dpp v21, v26, v49 row_newbcast:12 row_mask:0xf bank_mask:0xf
  v_fmac_f32_dpp v22, v26, v50 row_newbcast:12 row_mask:0xf bank_mask:0xf
  v_fmac_f32_dpp v23, v26, v51 row_newbcast:12 row_mask:0xf bank_mask:0xf
  buffer_load_dwordx4 v[96:99], v1, s[32:35], s73 offen offset:3456
  s_waitcnt vmcnt(17)
  v_lshlrev_b32 v44, 16, v100
  v_and_b32 v45, v63, v100
  v_lshlrev_b32 v46, 16, v101
  v_and_b32 v47, v63, v101
  v_lshlrev_b32 v48, 16, v102
  v_and_b32 v49, v63, v102
  v_lshlrev_b32 v50, 16, v103
  v_and_b32 v51, v63, v103
  v_fmac_f32_dpp v16, v26, v44 row_newbcast:2 row_mask:0xf bank_mask:0xf
  v_fmac_f32_dpp v17, v26, v45 row_newbcast:2 row_mask:0xf bank_mask:0xf
  v_fmac_f32_dpp v18, v26, v46 row_newbcast:2 row_mask:0xf bank_mask:0xf
  v_fmac_f32_dpp v19, v26, v47 row_newbcast:2 row_mask:0xf bank_mask:0xf
  v_fmac_f32_dpp v20, v26, v48 row_newbcast:2 row_mask:0xf bank_mask:0xf
  v_fmac_f32_dpp v21, v26, v49 row_newbcast:2 row_mask:0xf bank_mask:0xf
  v_fmac_f32_dpp v22, v26, v50 row_newbcast:2 row_mask:0xf bank_mask:0xf
  v_fmac_f32_dpp v23, v26, v51 row_newbcast:2 row_mask:0xf bank_mask:0xf
  s_add_u32 s60, s73, 4096
  buffer_load_dwordx4 v[100:103], v1, s[32:35], s60 offen offset:512
  s_waitcnt vmcnt(17)
  v_lshlrev_b32 v44, 16, v104
  v_and_b32 v45, v63, v104
  v_lshlrev_b32 v46, 16, v105
  v_and_b32 v47, v63, v105
  v_lshlrev_b32 v48, 16, v106
  v_and_b32 v49, v63, v106
  v_lshlrev_b32 v50, 16, v107
  v_and_b32 v51, v63, v107
  v_fmac_f32_dpp v16, v26, v44 row_newbcast:10 row_mask:0xf bank_mask:0xf
  v_fmac_f32_dpp v17, v26, v45 row_newbcast:10 row_mask:0xf bank_mask:0xf
  v_fmac_f32_dpp v18, v26, v46 row_newbcast:10 row_mask:0xf bank_mask:0xf
  v_fmac_f32_dpp v19, v26, v47 row_newbcast:10 row_mask:0xf bank_mask:0xf
  v_fmac_f32_dpp v20, v26, v48 row_newbcast:10 row_mask:0xf bank_mask:0xf
  v_fmac_f32_dpp v21, v26, v49 row_newbcast:10 row_mask:0xf bank_mask:0xf
  v_fmac_f32_dpp v22, v26, v50 row_newbcast:10 row_mask:0xf bank_mask:0xf
  v_fmac_f32_dpp v23, v26, v51 row_newbcast:10 row_mask:0xf bank_mask:0xf
  s_add_u32 s60, s73, 4096
  buffer_load_dwordx4 v[104:107], v1, s[32:35], s60 offen offset:1664
  s_waitcnt vmcnt(17)
  v_lshlrev_b32 v44, 16, v108
  v_and_b32 v45, v63, v108
  v_lshlrev_b32 v46, 16, v109
  v_and_b32 v47, v63, v109
  v_lshlrev_b32 v48, 16, v110
  v_and_b32 v49, v63, v110
  v_lshlrev_b32 v50, 16, v111
  v_and_b32 v51, v63, v111
  v_fmac_f32_dpp v16, v26, v44 row_newbcast:6 row_mask:0xf bank_mask:0xf
  v_fmac_f32_dpp v17, v26, v45 row_newbcast:6 row_mask:0xf bank_mask:0xf
  v_fmac_f32_dpp v18, v26, v46 row_newbcast:6 row_mask:0xf bank_mask:0xf
  v_fmac_f32_dpp v19, v26, v47 row_newbcast:6 row_mask:0xf bank_mask:0xf
  v_fmac_f32_dpp v20, v26, v48 row_newbcast:6 row_mask:0xf bank_mask:0xf
  v_fmac_f32_dpp v21, v26, v49 row_newbcast:6 row_mask:0xf bank_mask:0xf
  v_fmac_f32_dpp v22, v26, v50 row_newbcast:6 row_mask:0xf bank_mask:0xf
  v_fmac_f32_dpp v23, v26, v51 row_newbcast:6 row_mask:0xf bank_mask:0xf
  s_add_u32 s60, s73, 4096
  buffer_load_dwordx4 v[108:111], v1, s[32:35], s60 offen offset:2816
  s_waitcnt vmcnt(17)
  v_lshlrev_b32 v44, 16, v112
  v_and_b32 v45, v63, v112
  v_lshlrev_b32 v46, 16, v113
  v_and_b32 v47, v63, v113
  v_lshlrev_b32 v48, 16, v114
  v_and_b32 v49, v63, v114
  v_lshlrev_b32 v50, 16, v115
  v_and_b32 v51, v63, v115
  v_fmac_f32_dpp v16, v26, v44 row_newbcast:14 row_mask:0xf bank_mask:0xf
  v_fmac_f32_dpp v17, v26, v45 row_newbcast:14 row_mask:0xf bank_mask:0xf
  v_fmac_f32_dpp v18, v26, v46 row_newbcast:14 row_mask:0xf bank_mask:0xf
  v_fmac_f32_dpp v19, v26, v47 row_newbcast:14 row_mask:0xf bank_mask:0xf
  v_fmac_f32_dpp v20, v26, v48 row_newbcast:14 row_mask:0xf bank_mask:0xf
  v_fmac_f32_dpp v21, v26, v49 row_newbcast:14 row_mask:0xf bank_mask:0xf
  v_fmac_f32_dpp v22, v26, v50 row_newbcast:14 row_mask:0xf bank_mask:0xf
  v_fmac_f32_dpp v23, v26, v51 row_newbcast:14 row_mask:0xf bank_mask:0xf
  s_add_u32 s60, s73, 4096
  buffer_load_dwordx4 v[112:115], v1, s[32:35], s60 offen offset:3968
  s_waitcnt vmcnt(17)
  v_lshlrev_b32 v44, 16, v116
  v_and_b32 v45, v63, v116
  v_lshlrev_b32 v46, 16, v117
  v_and_b32 v47, v63, v117
  v_lshlrev_b32 v48, 16, v118
  v_and_b32 v49, v63, v118
  v_lshlrev_b32 v50, 16, v119
  v_and_b32 v51, v63, v119
  v_fmac_f32_dpp v16, v26, v44 row_newbcast:1 row_mask:0xf bank_mask:0xf
  v_fmac_f32_dpp v17, v26, v45 row_newbcast:1 row_mask:0xf bank_mask:0xf
  v_fmac_f32_dpp v18, v26, v46 row_newbcast:1 row_mask:0xf bank_mask:0xf
  v_fmac_f32_dpp v19, v26, v47 row_newbcast:1 row_mask:0xf bank_mask:0xf
  v_fmac_f32_dpp v20, v26, v48 row_newbcast:1 row_mask:0xf bank_mask:0xf
  v_fmac_f32_dpp v21, v26, v49 row_newbcast:1 row_mask:0xf bank_mask:0xf
  v_fmac_f32_dpp v22, v26, v50 row_newbcast:1 row_mask:0xf bank_mask:0xf
  v_fmac_f32_dpp v23, v26, v51 row_newbcast:1 row_mask:0xf bank_mask:0xf
  s_add_u32 s60, s73, 8192
  buffer_load_dwordx4 v[116:119], v1, s[32:35], s60 offen offset:1024
  s_waitcnt vmcnt(17)
  v_lshlrev_b32 v44, 16, v120
  v_and_b32 v45, v63, v120
  v_lshlrev_b32 v46, 16, v121
  v_and_b32 v47, v63, v121
  v_lshlrev_b32 v48, 16, v122
  v_and_b32 v49, v63, v122
  v_lshlrev_b32 v50, 16, v123
  v_and_b32 v51, v63, v123
  v_fmac_f32_dpp v16, v26, v44 row_newbcast:9 row_mask:0xf bank_mask:0xf
  v_fmac_f32_dpp v17, v26, v45 row_newbcast:9 row_mask:0xf bank_mask:0xf
  v_fmac_f32_dpp v18, v26, v46 row_newbcast:9 row_mask:0xf bank_mask:0xf
  v_fmac_f32_dpp v19, v26, v47 row_newbcast:9 row_mask:0xf bank_mask:0xf
  v_fmac_f32_dpp v20, v26, v48 row_newbcast:9 row_mask:0xf bank_mask:0xf
  v_fmac_f32_dpp v21, v26, v49 row_newbcast:9 row_mask:0xf bank_mask:0xf
  v_fmac_f32_dpp v22, v26, v50 row_newbcast:9 row_mask:0xf bank_mask:0xf
  v_fmac_f32_dpp v23, v26, v51 row_newbcast:9 row_mask:0xf bank_mask:0xf
  s_add_u32 s60, s73, 8192
  buffer_load_dwordx4 v[120:123], v1, s[32:35], s60 offen offset:2176
  s_waitcnt vmcnt(17)
  v_lshlrev_b32 v44, 16, v124
  v_and_b32 v45, v63, v124
  v_lshlrev_b32 v46, 16, v125
  v_and_b32 v47, v63, v125
  v_lshlrev_b32 v48, 16, v126
  v_and_b32 v49, v63, v126
  v_lshlrev_b32 v50, 16, v127
  v_and_b32 v51, v63, v127
  v_fmac_f32_dpp v16, v26, v44 row_newbcast:5 row_mask:0xf bank_mask:0xf
  v_fmac_f32_dpp v17, v26, v45 row_newbcast:5 row_mask:0xf bank_mask:0xf
  v_fmac_f32_dpp v18, v26, v46 row_newbcast:5 row_mask:0xf bank_mask:0xf
  v_fmac_f32_dpp v19, v26, v47 row_newbcast:5 row_mask:0xf bank_mask:0xf
  v_fmac_f32_dpp v20, v26, v48 row_newbcast:5 row_mask:0xf bank_mask:0xf
  v_fmac_f32_dpp v21, v26, v49 row_newbcast:5 row_mask:0xf bank_mask:0xf
  v_fmac_f32_dpp v22, v26, v50 row_newbcast:5 row_mask:0xf bank_mask:0xf
  v_fmac_f32_dpp v23, v26, v51 row_newbcast:5 row_mask:0xf bank_mask:0xf
  s_add_u32 s60, s73, 8192
  buffer_load_dwordx4 v[124:127], v1, s[32:35], s60 offen offset:3328
  s_waitcnt vmcnt(17)
  v_lshlrev_b32 v44, 16, v64
  v_and_b32 v45, v63, v64
  v_lshlrev_b32 v46, 16, v65
  v_and_b32 v47, v63, v65
  v_lshlrev_b32 v48, 16, v66
  v_and_b32 v49, v63, v66
  v_lshlrev_b32 v50, 16, v67
  v_and_b32 v51, v63, v67
  v_fmac_f32_dpp v16, v26, v44 row_newbcast:13 row_mask:0xf bank_mask:0xf
  v_fmac_f32_dpp v17, v26, v45 row_newbcast:13 row_mask:0xf bank_mask:0xf
  v_fmac_f32_dpp v18, v26, v46 row_newbcast:13 row_mask:0xf bank_mask:0xf
  v_fmac_f32_dpp v19, v26, v47 row_newbcast:13 row_mask:0xf bank_mask:0xf
  v_fmac_f32_dpp v20, v26, v48 row_newbcast:13 row_mask:0xf bank_mask:0xf
  v_fmac_f32_dpp v21, v26, v49 row_newbcast:13 row_mask:0xf bank_mask:0xf
  v_fmac_f32_dpp v22, v26, v50 row_newbcast:13 row_mask:0xf bank_mask:0xf
  v_fmac_f32_dpp v23, v26, v51 row_newbcast:13 row_mask:0xf bank_mask:0xf
  s_add_u32 s60, s73, 12288
  buffer_load_dwordx4 v[64:67], v1, s[32:35], s60 offen offset:384
  s_waitcnt vmcnt(17)
  v_lshlrev_b32 v44, 16, v68
  v_and_b32 v45, v63, v68
  v_lshlrev_b32 v46, 16, v69
  v_and_b32 v47, v63, v69
  v_lshlrev_b32 v48, 16, v70
  v_and_b32 v49, v63, v70
  v_lshlrev_b32 v50, 16, v71
  v_and_b32 v51, v63, v71
  v_fmac_f32_dpp v16, v26, v44 row_newbcast:3 row_mask:0xf bank_mask:0xf
  v_fmac_f32_dpp v17, v26, v45 row_newbcast:3 row_mask:0xf bank_mask:0xf
  v_fmac_f32_dpp v18, v26, v46 row_newbcast:3 row_mask:0xf bank_mask:0xf
  v_fmac_f32_dpp v19, v26, v47 row_newbcast:3 row_mask:0xf bank_mask:0xf
  v_fmac_f32_dpp v20, v26, v48 row_newbcast:3 row_mask:0xf bank_mask:0xf
  v_fmac_f32_dpp v21, v26, v49 row_newbcast:3 row_mask:0xf bank_mask:0xf
  v_fmac_f32_dpp v22, v26, v50 row_newbcast:3 row_mask:0xf bank_mask:0xf
  v_fmac_f32_dpp v23, v26, v51 row_newbcast:3 row_mask:0xf bank_mask:0xf
  s_add_u32 s60, s73, 12288
  buffer_load_dwordx4 v[68:71], v1, s[32:35], s60 offen offset:1536
  s_waitcnt vmcnt(17)
  v_lshlrev_b32 v44, 16, v72
  v_and_b32 v45, v63, v72
  v_lshlrev_b32 v46, 16, v73
  v_and_b32 v47, v63, v73
  v_lshlrev_b32 v48, 16, v74
  v_and_b32 v49, v63, v74
  v_lshlrev_b32 v50, 16, v75
  v_and_b32 v51, v63, v75
  v_fmac_f32_dpp v16, v26, v44 row_newbcast:11 row_mask:0xf bank_mask:0xf
  v_fmac_f32_dpp v17, v26, v45 row_newbcast:11 row_mask:0xf bank_mask:0xf
  v_fmac_f32_dpp v18, v26, v46 row_newbcast:11 row_mask:0xf bank_mask:0xf
  v_fmac_f32_dpp v19, v26, v47 row_newbcast:11 row_mask:0xf bank_mask:0xf
  v_fmac_f32_dpp v20, v26, v48 row_newbcast:11 row_mask:0xf bank_mask:0xf
  v_fmac_f32_dpp v21, v26, v49 row_newbcast:11 row_mask:0xf bank_mask:0xf
  v_fmac_f32_dpp v22, v26, v50 row_newbcast:11 row_mask:0xf bank_mask:0xf
  v_fmac_f32_dpp v23, v26, v51 row_newbcast:11 row_mask:0xf bank_mask:0xf
  s_add_u32 s60, s73, 12288
  buffer_load_dwordx4 v[72:75], v1, s[32:35], s60 offen offset:2688
  s_waitcnt vmcnt(17)
  v_lshlrev_b32 v44, 16, v76
  v_and_b32 v45, v63, v76
  v_lshlrev_b32 v46, 16, v77
  v_and_b32 v47, v63, v77
  v_lshlrev_b32 v48, 16, v78
  v_and_b32 v49, v63, v78
  v_lshlrev_b32 v50, 16, v79
  v_and_b32 v51, v63, v79
  v_fmac_f32_dpp v16, v26, v44 row_newbcast:7 row_mask:0xf bank_mask:0xf
  v_fmac_f32_dpp v17, v26, v45 row_newbcast:7 row_mask:0xf bank_mask:0xf
  v_fmac_f32_dpp v18, v26, v46 row_newbcast:7 row_mask:0xf bank_mask:0xf
  v_fmac_f32_dpp v19, v26, v47 row_newbcast:7 row_mask:0xf bank_mask:0xf
  v_fmac_f32_dpp v20, v26, v48 row_newbcast:7 row_mask:0xf bank_mask:0xf
  v_fmac_f32_dpp v21, v26, v49 row_newbcast:7 row_mask:0xf bank_mask:0xf
  v_fmac_f32_dpp v22, v26, v50 row_newbcast:7 row_mask:0xf bank_mask:0xf
  v_fmac_f32_dpp v23, v26, v51 row_newbcast:7 row_mask:0xf bank_mask:0xf
  s_add_u32 s60, s73, 12288
  buffer_load_dwordx4 v[76:79], v1, s[32:35], s60 offen offset:3840
  s_waitcnt vmcnt(17)
  v_lshlrev_b32 v44, 16, v80
  v_and_b32 v45, v63, v80
  v_lshlrev_b32 v46, 16, v81
  v_and_b32 v47, v63, v81
  v_lshlrev_b32 v48, 16, v82
  v_and_b32 v49, v63, v82
  v_lshlrev_b32 v50, 16, v83
  v_and_b32 v51, v63, v83
  v_fmac_f32_dpp v16, v26, v44 row_newbcast:15 row_mask:0xf bank_mask:0xf
  v_fmac_f32_dpp v17, v26, v45 row_newbcast:15 row_mask:0xf bank_mask:0xf
  v_fmac_f32_dpp v18, v26, v46 row_newbcast:15 row_mask:0xf bank_mask:0xf
  v_fmac_f32_dpp v19, v26, v47 row_newbcast:15 row_mask:0xf bank_mask:0xf
  v_fmac_f32_dpp v20, v26, v48 row_newbcast:15 row_mask:0xf bank_mask:0xf
  v_fmac_f32_dpp v21, v26, v49 row_newbcast:15 row_mask:0xf bank_mask:0xf
  v_fmac_f32_dpp v22, v26, v50 row_newbcast:15 row_mask:0xf bank_mask:0xf
  v_fmac_f32_dpp v23, v26, v51 row_newbcast:15 row_mask:0xf bank_mask:0xf
  s_add_u32 s60, s73, 16384
  buffer_load_dwordx4 v[80:83], v1, s[32:35], s60 offen offset:896
  v_readlane_b32 s69, v24, 0
  v_readlane_b32 s70, v24, 16
  v_readlane_b32 s71, v24, 32
  v_readlane_b32 s72, v24, 48
  v_mov_b32 v44, s69
  v_max_f32 v44, s70, v44
  v_max_f32 v44, s71, v44
  v_max_f32 v44, s72, v44
  v_sub_f32 v45, v24, v44
  v_exp_f32 v45, v45
  s_nop 0
  v_mul_f32 v16, v16, v45
  v_mul_f32 v17, v17, v45
  v_mul_f32 v18, v18, v45
  v_mul_f32 v19, v19, v45
  v_mul_f32 v20, v20, v45
  v_mul_f32 v21, v21, v45
  v_mul_f32 v22, v22, v45
  v_mul_f32 v23, v23, v45
  v_mul_f32 v25, v25, v45
  s_nop 1
  v_add_f32_dpp v25, v25, v25 quad_perm:[1,0,3,2] row_mask:0xf bank_mask:0xf
  s_nop 1
  v_add_f32_dpp v25, v25, v25 quad_perm:[2,3,0,1] row_mask:0xf bank_mask:0xf
  s_nop 1
  v_add_f32_dpp v25, v25, v25 row_half_mirror row_mask:0xf bank_mask:0xf
  s_nop 1
  v_add_f32_dpp v25, v25, v25 row_ror:8 row_mask:0xf bank_mask:0xf
  s_nop 0
  v_readlane_b32 s69, v25, 0
  v_readlane_b32 s70, v25, 16
  v_readlane_b32 s71, v25, 32
  v_readlane_b32 s72, v25, 48
  v_mov_b32 v45, s69
  v_add_f32 v45, s70, v45
  v_add_f32 v45, s71, v45
  v_add_f32 v45, s72, v45
  v_permlane32_swap_b32 v16, v20
  v_permlane32_swap_b32 v17, v21
  v_permlane32_swap_b32 v18, v22
  v_permlane32_swap_b32 v19, v23
  v_add_f32 v16, v16, v20
  v_add_f32 v17, v17, v21
  v_add_f32 v18, v18, v22
  v_add_f32 v19, v19, v23
  s_nop 0
  v_permlane16_swap_b32 v16, v18
  v_permlane16_swap_b32 v17, v19
  v_add_f32 v16, v16, v18
  v_add_f32 v17, v17, v19
  ds_write_b64 v60, v[16:17] offset:40960
  s_lshl_b32 s69, s56, 3
  v_mov_b32 v46, s69
  ds_write_b64 v46, v[44:45] offset:49152
  s_cmp_lt_u32 s56, 8
  s_cbranch_scc1 L_old
  s_mul_i32 s69, s56, 2304
  s_add_u32 s69, s69, 50176
  v_lshl_add_u32 v44, v1, 1, s69
  ds_write_b128 v44, v[28:31]
  ds_write_b128 v44, v[32:35] offset:16
  v_permlane32_swap_b32 v36, v40
  v_permlane32_swap_b32 v37, v41
  v_permlane32_swap_b32 v38, v42
  v_permlane32_swap_b32 v39, v43
  v_add_f32 v36, v36, v40
  v_add_f32 v37, v37, v41
  v_add_f32 v38, v38, v42
  v_add_f32 v39, v39, v43
  s_nop 0
  v_permlane16_swap_b32 v36, v38
  v_permlane16_swap_b32 v37, v39
  v_add_f32 v36, v36, v38
  v_add_f32 v37, v37, v39
  s_nop 0
  v_add_f32_dpp v36, v36, v36 row_ror:8 row_mask:0xf bank_mask:0x3
  s_nop 1
  v_add_f32_dpp v36, v37, v37 row_ror:8 row_mask:0xf bank_mask:0xc
  v_and_b32 v44, 63, v0
  v_and_b32 v45, 7, v44
  v_lshlrev_b32 v45, 5, v45
  v_lshrrev_b32 v46, 5, v44
  v_lshl_add_u32 v45, v46, 4, v45
  v_bfe_u32 v46, v44, 4, 1
  v_lshl_add_u32 v45, v46, 3, v45
  v_bfe_u32 v46, v44, 3, 1
  v_lshl_add_u32 v45, v46, 2, v45
  s_mul_i32 s69, s56, 2304
  s_add_u32 s69, s69, 50176
  v_add_u32 v45, s69, v45
  ds_write_b32 v45, v36 offset:2048
  s_waitcnt lgkmcnt(0)
  s_barrier
  s_barrier
  s_branch L_t4
L_old:
  v_and_b32 v44, 63, v0
  v_and_b32 v45, 7, v44
  v_lshrrev_b32 v46, 3, v44
  v_lshlrev_b32 v47, 3, v45
  v_lshlrev_b32 v45, 9, v45
  v_lshl_add_u32 v45, v46, 2, v45
  s_lshl_b32 s69, s56, 6
  v_add_u32 v45, s69, v45
  s_waitcnt lgkmcnt(0)
  s_barrier
  ds_read_b64 v[16:17], v47 offset:49152
  ds_read_b64 v[18:19], v47 offset:49216
  ds_read_b32 v20, v45 offset:40960
  ds_read_b32 v21, v45 offset:45056
  ds_read_b32 v22, v45 offset:40992
  ds_read_b32 v23, v45 offset:45088
  s_waitcnt lgkmcnt(0)
  v_max_f32 v44, v16, v18
  s_nop 1
  v_max_f32_dpp v44, v44, v44 quad_perm:[1,0,3,2] row_mask:0xf bank_mask:0xf
  s_nop 1
  v_max_f32_dpp v44, v44, v44 quad_perm:[2,3,0,1] row_mask:0xf bank_mask:0xf
  s_nop 1
  v_max_f32_dpp v44, v44, v44 row_half_mirror row_mask:0xf bank_mask:0xf
  v_sub_f32 v16, v16, v44
  v_sub_f32 v18, v18, v44
  v_exp_f32 v16, v16
  v_exp_f32 v18, v18
  v_mul_f32 v17, v16, v17
  v_mul_f32 v20, v16, v20
  v_mul_f32 v22, v16, v22
  v_fmac_f32 v17, v18, v19
  v_fmac_f32 v20, v18, v21
  v_fmac_f32 v22, v18, v23
  v_add_f32_dpp v17, v17, v17 quad_perm:[1,0,3,2] row_mask:0xf bank_mask:0xf
  v_add_f32_dpp v20, v20, v20 quad_perm:[1,0,3,2] row_mask:0xf bank_mask:0xf
  v_add_f32_dpp v22, v22, v22 quad_perm:[1,0,3,2] row_mask:0xf bank_mask:0xf
  v_add_f32_dpp v17, v17, v17 quad_perm:[2,3,0,1] row_mask:0xf bank_mask:0xf
  v_add_f32_dpp v20, v20, v20 quad_perm:[2,3,0,1] row_mask:0xf bank_mask:0xf
  v_add_f32_dpp v22, v22, v22 quad_perm:[2,3,0,1] row_mask:0xf bank_mask:0xf
  v_add_f32_dpp v17, v17, v17 row_half_mirror row_mask:0xf bank_mask:0xf
  v_add_f32_dpp v20, v20, v20 row_half_mirror row_mask:0xf bank_mask:0xf
  v_add_f32_dpp v22, v22, v22 row_half_mirror row_mask:0xf bank_mask:0xf
  v_rcp_f32 v17, v17
  s_nop 0
  v_mul_f32 v20, v20, v17
  v_mul_f32 v22, v22, v17
  v_cvt_pk_bf16_f32 v61, v20, v20
  v_lshlrev_b32 v61, 16, v61
  v_cvt_pk_bf16_f32 v62, v22, v22
  v_lshlrev_b32 v62, 16, v62
  v_mul_f32 v61, s67, v61
  v_mul_f32 v62, s67, v62
  v_readlane_b32 s76, v61, 0
  v_readlane_b32 s77, v61, 8
  v_readlane_b32 s78, v61, 16
  v_readlane_b32 s79, v61, 24
  v_readlane_b32 s80, v61, 32
  v_readlane_b32 s81, v61, 40
  v_readlane_b32 s82, v61, 48
  v_readlane_b32 s83, v61, 56
  s_waitcnt vmcnt(15)
  v_lshlrev_b32 v44, 16, v84
  v_and_b32 v45, v63, v84
  v_lshlrev_b32 v46, 16, v85
  v_and_b32 v47, v63, v85
  v_lshlrev_b32 v48, 16, v86
  v_and_b32 v49, v63, v86
  v_lshlrev_b32 v50, 16, v87
  v_and_b32 v51, v63, v87
  v_fmac_f32 v28, s76, v44
  v_fmac_f32 v29, s76, v45
  v_fmac_f32 v30, s76, v46
  v_fmac_f32 v31, s76, v47
  v_fmac_f32 v32, s76, v48
  v_fmac_f32 v33, s76, v49
  v_fmac_f32 v34, s76, v50
  v_fmac_f32 v35, s76, v51
  s_waitcnt vmcnt(14)
  v_lshlrev_b32 v44, 16, v88
  v_and_b32 v45, v63, v88
  v_lshlrev_b32 v46, 16, v89
  v_and_b32 v47, v63, v89
  v_lshlrev_b32 v48, 16, v90
  v_and_b32 v49, v63, v90
  v_lshlrev_b32 v50, 16, v91
  v_and_b32 v51, v63, v91
  v_fmac_f32 v28, s77, v44
  v_fmac_f32 v29, s77, v45
  v_fmac_f32 v30, s77, v46
  v_fmac_f32 v31, s77, v47
  v_fmac_f32 v32, s77, v48
  v_fmac_f32 v33, s77, v49
  v_fmac_f32 v34, s77, v50
  v_fmac_f32 v35, s77, v51
  s_waitcnt vmcnt(13)
  v_lshlrev_b32 v44, 16, v92
  v_and_b32 v45, v63, v92
  v_lshlrev_b32 v46, 16, v93
  v_and_b32 v47, v63, v93
  v_lshlrev_b32 v48, 16, v94
  v_and_b32 v49, v63, v94
  v_lshlrev_b32 v50, 16, v95
  v_and_b32 v51, v63, v95
  v_fmac_f32 v28, s78, v44
  v_fmac_f32 v29, s78, v45
  v_fmac_f32 v30, s78, v46
  v_fmac_f32 v31, s78, v47
  v_fmac_f32 v32, s78, v48
  v_fmac_f32 v33, s78, v49
  v_fmac_f32 v34, s78, v50
  v_fmac_f32 v35, s78, v51
  s_waitcnt vmcnt(12)
  v_lshlrev_b32 v44, 16, v96
  v_and_b32 v45, v63, v96
  v_lshlrev_b32 v46, 16, v97
  v_and_b32 v47, v63, v97
  v_lshlrev_b32 v48, 16, v98
  v_and_b32 v49, v63, v98
  v_lshlrev_b32 v50, 16, v99
  v_and_b32 v51, v63, v99
  v_fmac_f32 v28, s79, v44
  v_fmac_f32 v29, s79, v45
  v_fmac_f32 v30, s79, v46
  v_fmac_f32 v31, s79, v47
  v_fmac_f32 v32, s79, v48
  v_fmac_f32 v33, s79, v49
  v_fmac_f32 v34, s79, v50
  v_fmac_f32 v35, s79, v51
  s_waitcnt vmcnt(11)
  v_lshlrev_b32 v44, 16, v100
  v_and_b32 v45, v63, v100
  v_lshlrev_b32 v46, 16, v101
  v_and_b32 v47, v63, v101
  v_lshlrev_b32 v48, 16, v102
  v_and_b32 v49, v63, v102
  v_lshlrev_b32 v50, 16, v103
  v_and_b32 v51, v63, v103
  v_fmac_f32 v28, s80, v44
  v_fmac_f32 v29, s80, v45
  v_fmac_f32 v30, s80, v46
  v_fmac_f32 v31, s80, v47
  v_fmac_f32 v32, s80, v48
  v_fmac_f32 v33, s80, v49
  v_fmac_f32 v34, s80, v50
  v_fmac_f32 v35, s80, v51
  s_waitcnt vmcnt(10)
  v_lshlrev_b32 v44, 16, v104
  v_and_b32 v45, v63, v104
  v_lshlrev_b32 v46, 16, v105
  v_and_b32 v47, v63, v105
  v_lshlrev_b32 v48, 16, v106
  v_and_b32 v49, v63, v106
  v_lshlrev_b32 v50, 16, v107
  v_and_b32 v51, v63, v107
  v_fmac_f32 v28, s81, v44
  v_fmac_f32 v29, s81, v45
  v_fmac_f32 v30, s81, v46
  v_fmac_f32 v31, s81, v47
  v_fmac_f32 v32, s81, v48
  v_fmac_f32 v33, s81, v49
  v_fmac_f32 v34, s81, v50
  v_fmac_f32 v35, s81, v51
  s_waitcnt vmcnt(9)
  v_lshlrev_b32 v44, 16, v108
  v_and_b32 v45, v63, v108
  v_lshlrev_b32 v46, 16, v109
  v_and_b32 v47, v63, v109
  v_lshlrev_b32 v48, 16, v110
  v_and_b32 v49, v63, v110
  v_lshlrev_b32 v50, 16, v111
  v_and_b32 v51, v63, v111
  v_fmac_f32 v28, s82, v44
  v_fmac_f32 v29, s82, v45
  v_fmac_f32 v30, s82, v46
  v_fmac_f32 v31, s82, v47
  v_fmac_f32 v32, s82, v48
  v_fmac_f32 v33, s82, v49
  v_fmac_f32 v34, s82, v50
  v_fmac_f32 v35, s82, v51
  s_waitcnt vmcnt(8)
  v_lshlrev_b32 v44, 16, v112
  v_and_b32 v45, v63, v112
  v_lshlrev_b32 v46, 16, v113
  v_and_b32 v47, v63, v113
  v_lshlrev_b32 v48, 16, v114
  v_and_b32 v49, v63, v114
  v_lshlrev_b32 v50, 16, v115
  v_and_b32 v51, v63, v115
  v_fmac_f32 v28, s83, v44
  v_fmac_f32 v29, s83, v45
  v_fmac_f32 v30, s83, v46
  v_fmac_f32 v31, s83, v47
  v_fmac_f32 v32, s83, v48
  v_fmac_f32 v33, s83, v49
  v_fmac_f32 v34, s83, v50
  v_fmac_f32 v35, s83, v51
  v_readlane_b32 s76, v62, 0
  v_readlane_b32 s77, v62, 8
  v_readlane_b32 s78, v62, 16
  v_readlane_b32 s79, v62, 24
  v_readlane_b32 s80, v62, 32
  v_readlane_b32 s81, v62, 40
  v_readlane_b32 s82, v62, 48
  v_readlane_b32 s83, v62, 56
  s_waitcnt vmcnt(7)
  v_lshlrev_b32 v44, 16, v116
  v_and_b32 v45, v63, v116
  v_lshlrev_b32 v46, 16, v117
  v_and_b32 v47, v63, v117
  v_lshlrev_b32 v48, 16, v118
  v_and_b32 v49, v63, v118
  v_lshlrev_b32 v50, 16, v119
  v_and_b32 v51, v63, v119
  v_fmac_f32 v28, s76, v44
  v_fmac_f32 v29, s76, v45
  v_fmac_f32 v30, s76, v46
  v_fmac_f32 v31, s76, v47
  v_fmac_f32 v32, s76, v48
  v_fmac_f32 v33, s76, v49
  v_fmac_f32 v34, s76, v50
  v_fmac_f32 v35, s76, v51
  s_waitcnt vmcnt(6)
  v_lshlrev_b32 v44, 16, v120
  v_and_b32 v45, v63, v120
  v_lshlrev_b32 v46, 16, v121
  v_and_b32 v47, v63, v121
  v_lshlrev_b32 v48, 16, v122
  v_and_b32 v49, v63, v122
  v_lshlrev_b32 v50, 16, v123
  v_and_b32 v51, v63, v123
  v_fmac_f32 v28, s77, v44
  v_fmac_f32 v29, s77, v45
  v_fmac_f32 v30, s77, v46
  v_fmac_f32 v31, s77, v47
  v_fmac_f32 v32, s77, v48
  v_fmac_f32 v33, s77, v49
  v_fmac_f32 v34, s77, v50
  v_fmac_f32 v35, s77, v51
  s_waitcnt vmcnt(5)
  v_lshlrev_b32 v44, 16, v124
  v_and_b32 v45, v63, v124
  v_lshlrev_b32 v46, 16, v125
  v_and_b32 v47, v63, v125
  v_lshlrev_b32 v48, 16, v126
  v_and_b32 v49, v63, v126
  v_lshlrev_b32 v50, 16, v127
  v_and_b32 v51, v63, v127
  v_fmac_f32 v28, s78, v44
  v_fmac_f32 v29, s78, v45
  v_fmac_f32 v30, s78, v46
  v_fmac_f32 v31, s78, v47
  v_fmac_f32 v32, s78, v48
  v_fmac_f32 v33, s78, v49
  v_fmac_f32 v34, s78, v50
  v_fmac_f32 v35, s78, v51
  s_waitcnt vmcnt(4)
  v_lshlrev_b32 v44, 16, v64
  v_and_b32 v45, v63, v64
  v_lshlrev_b32 v46, 16, v65
  v_and_b32 v47, v63, v65
  v_lshlrev_b32 v48, 16, v66
  v_and_b32 v49, v63, v66
  v_lshlrev_b32 v50, 16, v67
  v_and_b32 v51, v63, v67
  v_fmac_f32 v28, s79, v44
  v_fmac_f32 v29, s79, v45
  v_fmac_f32 v30, s79, v46
  v_fmac_f32 v31, s79, v47
  v_fmac_f32 v32, s79, v48
  v_fmac_f32 v33, s79, v49
  v_fmac_f32 v34, s79, v50
  v_fmac_f32 v35, s79, v51
  s_waitcnt vmcnt(3)
  v_lshlrev_b32 v44, 16, v68
  v_and_b32 v45, v63, v68
  v_lshlrev_b32 v46, 16, v69
  v_and_b32 v47, v63, v69
  v_lshlrev_b32 v48, 16, v70
  v_and_b32 v49, v63, v70
  v_lshlrev_b32 v50, 16, v71
  v_and_b32 v51, v63, v71
  v_fmac_f32 v28, s80, v44
  v_fmac_f32 v29, s80, v45
  v_fmac_f32 v30, s80, v46
  v_fmac_f32 v31, s80, v47
  v_fmac_f32 v32, s80, v48
  v_fmac_f32 v33, s80, v49
  v_fmac_f32 v34, s80, v50
  v_fmac_f32 v35, s80, v51
  s_waitcnt vmcnt(2)
  v_lshlrev_b32 v44, 16, v72
  v_and_b32 v45, v63, v72
  v_lshlrev_b32 v46, 16, v73
  v_and_b32 v47, v63, v73
  v_lshlrev_b32 v48, 16, v74
  v_and_b32 v49, v63, v74
  v_lshlrev_b32 v50, 16, v75
  v_and_b32 v51, v63, v75
  v_fmac_f32 v28, s81, v44
  v_fmac_f32 v29, s81, v45
  v_fmac_f32 v30, s81, v46
  v_fmac_f32 v31, s81, v47
  v_fmac_f32 v32, s81, v48
  v_fmac_f32 v33, s81, v49
  v_fmac_f32 v34, s81, v50
  v_fmac_f32 v35, s81, v51
  s_waitcnt vmcnt(1)
  v_lshlrev_b32 v44, 16, v76
  v_and_b32 v45, v63, v76
  v_lshlrev_b32 v46, 16, v77
  v_and_b32 v47, v63, v77
  v_lshlrev_b32 v48, 16, v78
  v_and_b32 v49, v63, v78
  v_lshlrev_b32 v50, 16, v79
  v_and_b32 v51, v63, v79
  v_fmac_f32 v28, s82, v44
  v_fmac_f32 v29, s82, v45
  v_fmac_f32 v30, s82, v46
  v_fmac_f32 v31, s82, v47
  v_fmac_f32 v32, s82, v48
  v_fmac_f32 v33, s82, v49
  v_fmac_f32 v34, s82, v50
  v_fmac_f32 v35, s82, v51
  s_waitcnt vmcnt(0)
  v_lshlrev_b32 v44, 16, v80
  v_and_b32 v45, v63, v80
  v_lshlrev_b32 v46, 16, v81
  v_and_b32 v47, v63, v81
  v_lshlrev_b32 v48, 16, v82
  v_and_b32 v49, v63, v82
  v_lshlrev_b32 v50, 16, v83
  v_and_b32 v51, v63, v83
  v_fmac_f32 v28, s83, v44
  v_fmac_f32 v29, s83, v45
  v_fmac_f32 v30, s83, v46
  v_fmac_f32 v31, s83, v47
  v_fmac_f32 v32, s83, v48
  v_fmac_f32 v33, s83, v49
  v_fmac_f32 v34, s83, v50
  v_fmac_f32 v35, s83, v51
  s_mul_i32 s69, s56, 2304
  s_add_u32 s69, s69, 50176
  v_lshl_add_u32 v44, v1, 1, s69
  ds_write_b128 v44, v[28:31]
  ds_write_b128 v44, v[32:35] offset:16
  v_lshlrev_b32 v44, 16, v52
  v_and_b32 v45, v63, v52
  v_lshlrev_b32 v46, 16, v53
  v_and_b32 v47, v63, v53
  v_lshlrev_b32 v48, 16, v54
  v_and_b32 v49, v63, v54
  v_lshlrev_b32 v50, 16, v55
  v_and_b32 v51, v63, v55
  v_fmac_f32 v36, v61, v44
  v_fmac_f32 v37, v61, v45
  v_fmac_f32 v38, v61, v46
  v_fmac_f32 v39, v61, v47
  v_fmac_f32 v40, v61, v48
  v_fmac_f32 v41, v61, v49
  v_fmac_f32 v42, v61, v50
  v_fmac_f32 v43, v61, v51
  v_lshlrev_b32 v44, 16, v56
  v_and_b32 v45, v63, v56
  v_lshlrev_b32 v46, 16, v57
  v_and_b32 v47, v63, v57
  v_lshlrev_b32 v48, 16, v58
  v_and_b32 v49, v63, v58
  v_lshlrev_b32 v50, 16, v59
  v_and_b32 v51, v63, v59
  v_fmac_f32 v36, v62, v44
  v_fmac_f32 v37, v62, v45
  v_fmac_f32 v38, v62, v46
  v_fmac_f32 v39, v62, v47
  v_fmac_f32 v40, v62, v48
  v_fmac_f32 v41, v62, v49
  v_fmac_f32 v42, v62, v50
  v_fmac_f32 v43, v62, v51
  v_permlane32_swap_b32 v36, v40
  v_permlane32_swap_b32 v37, v41
  v_permlane32_swap_b32 v38, v42
  v_permlane32_swap_b32 v39, v43
  v_add_f32 v36, v36, v40
  v_add_f32 v37, v37, v41
  v_add_f32 v38, v38, v42
  v_add_f32 v39, v39, v43
  s_nop 0
  v_permlane16_swap_b32 v36, v38
  v_permlane16_swap_b32 v37, v39
  v_add_f32 v36, v36, v38
  v_add_f32 v37, v37, v39
  s_nop 0
  v_add_f32_dpp v36, v36, v36 row_ror:8 row_mask:0xf bank_mask:0x3
  s_nop 1
  v_add_f32_dpp v36, v37, v37 row_ror:8 row_mask:0xf bank_mask:0xc
  v_and_b32 v44, 63, v0
  v_and_b32 v45, 7, v44
  v_lshlrev_b32 v45, 5, v45
  v_lshrrev_b32 v46, 5, v44
  v_lshl_add_u32 v45, v46, 4, v45
  v_bfe_u32 v46, v44, 4, 1
  v_lshl_add_u32 v45, v46, 3, v45
  v_bfe_u32 v46, v44, 3, 1
  v_lshl_add_u32 v45, v46, 2, v45
  s_mul_i32 s69, s56, 2304
  s_add_u32 s69, s69, 50176
  v_add_u32 v45, s69, v45
  ds_write_b32 v45, v36 offset:2048
  s_waitcnt lgkmcnt(0)
  s_barrier
L_t4:
  s_cmp_ge_u32 s56, 5
  s_cbranch_scc1 L_t4skip
  v_lshlrev_b32 v44, 3, v0
  v_add_u32 v45, 50176, v44
  ds_read_b64 v[64:65], v45 offset:0
  ds_read_b64 v[66:67], v45 offset:2304
  ds_read_b64 v[68:69], v45 offset:4608
  ds_read_b64 v[70:71], v45 offset:6912
  ds_read_b64 v[72:73], v45 offset:9216
  ds_read_b64 v[74:75], v45 offset:11520
  ds_read_b64 v[76:77], v45 offset:13824
  ds_read_b64 v[78:79], v45 offset:16128
  ds_read_b64 v[80:81], v45 offset:18432
  ds_read_b64 v[82:83], v45 offset:20736
  ds_read_b64 v[84:85], v45 offset:23040
  ds_read_b64 v[86:87], v45 offset:25344
  ds_read_b64 v[88:89], v45 offset:27648
  ds_read_b64 v[90:91], v45 offset:29952
  ds_read_b64 v[92:93], v45 offset:32256
  ds_read_b64 v[94:95], v45 offset:34560
  v_mov_b32 v46, 0x7ff00000
  v_cmp_gt_u32 vcc, 2304, v44
  s_nop 1
  v_cndmask_b32 v44, v46, v44, vcc
  s_mul_i32 s71, s2, 2304
  s_waitcnt lgkmcnt(0)
  v_add_f32 v64, v64, v80
  v_add_f32 v65, v65, v81
  v_add_f32 v66, v66, v82
  v_add_f32 v67, v67, v83
  v_add_f32 v68, v68, v84
  v_add_f32 v69, v69, v85
  v_add_f32 v70, v70, v86
  v_add_f32 v71, v71, v87
  v_add_f32 v72, v72, v88
  v_add_f32 v73, v73, v89
  v_add_f32 v74, v74, v90
  v_add_f32 v75, v75, v91
  v_add_f32 v76, v76, v92
  v_add_f32 v77, v77, v93
  v_add_f32 v78, v78, v94
  v_add_f32 v79, v79, v95
  v_add_f32 v64, v64, v72
  v_add_f32 v65, v65, v73
  v_add_f32 v66, v66, v74
  v_add_f32 v67, v67, v75
  v_add_f32 v68, v68, v76
  v_add_f32 v69, v69, v77
  v_add_f32 v70, v70, v78
  v_add_f32 v71, v71, v79
  v_add_f32 v64, v64, v68
  v_add_f32 v65, v65, v69
  v_add_f32 v66, v66, v70
  v_add_f32 v67, v67, v71
  v_add_f32 v64, v64, v66
  v_add_f32 v65, v65, v67
  buffer_store_dwordx2 v[64:65], v44, s[48:51], s71 offen sc1
  s_waitcnt vmcnt(0)
L_t4skip:
  s_barrier
  s_cmp_lg_u32 s56, 0
  s_cbranch_scc1 L_t5skip
  v_mov_b32 v44, 1
  s_lshl_b32 s69, s57, 4
  v_lshlrev_b32 v45, 20, v0
  buffer_atomic_add v44, v45, s[52:55], s69 offen sc0 sc1
  s_waitcnt vmcnt(0)
  v_mov_b32 v46, 123904
  v_readfirstlane_b32 s69, v44
  s_nop 1
  v_mov_b32 v44, s69
  ds_write_b32 v46, v44
  s_waitcnt lgkmcnt(0)
L_t5skip:
  s_barrier
  v_mov_b32 v46, 123904
  ds_read_b32 v44, v46
  s_waitcnt lgkmcnt(0)
  v_readfirstlane_b32 s69, v44
  s_cmp_lg_u32 s69, 31
  s_cbranch_scc1 L_end
  s_mul_i32 s69, s57, 73728
  s_mul_i32 s70, s56, 4608
  s_add_u32 s69, s69, s70
  s_add_u32 s71, s69, 4096
  v_mov_b32 v46, 0x7ff00000
  v_cmp_gt_u32 vcc, 512, v1
  s_nop 1
  v_cndmask_b32 v45, v46, v1, vcc
  buffer_load_dwordx4 v[64:67], v1, s[48:51], s69 offen offset:0 sc1
  buffer_load_dwordx4 v[68:71], v1, s[48:51], s69 offen offset:1024 sc1
  buffer_load_dwordx4 v[72:75], v1, s[48:51], s69 offen offset:2048 sc1
  buffer_load_dwordx4 v[76:79], v1, s[48:51], s69 offen offset:3072 sc1
  buffer_load_dwordx4 v[80:83], v45, s[48:51], s71 offen sc1
  v_add_u32 v44, s70, v1
  s_waitcnt vmcnt(4)
  ds_write_b128 v44, v[64:67] offset:0
  s_waitcnt vmcnt(3)
  ds_write_b128 v44, v[68:71] offset:1024
  s_waitcnt vmcnt(2)
  ds_write_b128 v44, v[72:75] offset:2048
  s_waitcnt vmcnt(1)
  ds_write_b128 v44, v[76:79] offset:3072
  s_waitcnt vmcnt(0)
  s_mov_b32 exec_hi, 0
  ds_write_b128 v44, v[80:83] offset:4096
  s_mov_b64 exec, -1
  s_waitcnt lgkmcnt(0)
  s_barrier
  s_cmp_ge_u32 s56, 5
  s_cbranch_scc1 L_end
  v_lshlrev_b32 v44, 3, v0
  v_add_u32 v45, 36864, v44
  ds_read_b64 v[64:65], v44 offset:0
  ds_read_b64 v[66:67], v44 offset:2304
  ds_read_b64 v[68:69], v44 offset:4608
  ds_read_b64 v[70:71], v44 offset:6912
  ds_read_b64 v[72:73], v44 offset:9216
  ds_read_b64 v[74:75], v44 offset:11520
  ds_read_b64 v[76:77], v44 offset:13824
  ds_read_b64 v[78:79], v44 offset:16128
  ds_read_b64 v[80:81], v44 offset:18432
  ds_read_b64 v[82:83], v44 offset:20736
  ds_read_b64 v[84:85], v44 offset:23040
  ds_read_b64 v[86:87], v44 offset:25344
  ds_read_b64 v[88:89], v44 offset:27648
  ds_read_b64 v[90:91], v44 offset:29952
  ds_read_b64 v[92:93], v44 offset:32256
  ds_read_b64 v[94:95], v44 offset:34560
  ds_read_b64 v[96:97], v45 offset:0
  ds_read_b64 v[98:99], v45 offset:2304
  ds_read_b64 v[100:101], v45 offset:4608
  ds_read_b64 v[102:103], v45 offset:6912
  ds_read_b64 v[104:105], v45 offset:9216
  ds_read_b64 v[106:107], v45 offset:11520
  ds_read_b64 v[108:109], v45 offset:13824
  ds_read_b64 v[110:111], v45 offset:16128
  ds_read_b64 v[112:113], v45 offset:18432
  ds_read_b64 v[114:115], v45 offset:20736
  ds_read_b64 v[116:117], v45 offset:23040
  ds_read_b64 v[118:119], v45 offset:25344
  ds_read_b64 v[120:121], v45 offset:27648
  ds_read_b64 v[122:123], v45 offset:29952
  ds_read_b64 v[124:125], v45 offset:32256
  ds_read_b64 v[126:127], v45 offset:34560
  v_lshlrev_b32 v44, 2, v0
  v_mov_b32 v46, 0x7ff00000
  v_cmp_gt_u32 vcc, 1152, v44
  s_nop 1
  v_cndmask_b32 v44, v46, v44, vcc
  s_waitcnt lgkmcnt(0)
  v_add_f32 v64, v64, v96
  v_add_f32 v65, v65, v97
  v_add_f32 v66, v66, v98
  v_add_f32 v67, v67, v99
  v_add_f32 v68, v68, v100
  v_add_f32 v69, v69, v101
  v_add_f32 v70, v70, v102
  v_add_f32 v71, v71, v103
  v_add_f32 v72, v72, v104
  v_add_f32 v73, v73, v105
  v_add_f32 v74, v74, v106
  v_add_f32 v75, v75, v107
  v_add_f32 v76, v76, v108
  v_add_f32 v77, v77, v109
  v_add_f32 v78, v78, v110
  v_add_f32 v79, v79, v111
  v_add_f32 v80, v80, v112
  v_add_f32 v81, v81, v113
  v_add_f32 v82, v82, v114
  v_add_f32 v83, v83, v115
  v_add_f32 v84, v84, v116
  v_add_f32 v85, v85, v117
  v_add_f32 v86, v86, v118
  v_add_f32 v87, v87, v119
  v_add_f32 v88, v88, v120
  v_add_f32 v89, v89, v121
  v_add_f32 v90, v90, v122
  v_add_f32 v91, v91, v123
  v_add_f32 v92, v92, v124
  v_add_f32 v93, v93, v125
  v_add_f32 v94, v94, v126
  v_add_f32 v95, v95, v127
  v_add_f32 v64, v64, v80
  v_add_f32 v65, v65, v81
  v_add_f32 v66, v66, v82
  v_add_f32 v67, v67, v83
  v_add_f32 v68, v68, v84
  v_add_f32 v69, v69, v85
  v_add_f32 v70, v70, v86
  v_add_f32 v71, v71, v87
  v_add_f32 v72, v72, v88
  v_add_f32 v73, v73, v89
  v_add_f32 v74, v74, v90
  v_add_f32 v75, v75, v91
  v_add_f32 v76, v76, v92
  v_add_f32 v77, v77, v93
  v_add_f32 v78, v78, v94
  v_add_f32 v79, v79, v95
  v_add_f32 v64, v64, v72
  v_add_f32 v65, v65, v73
  v_add_f32 v66, v66, v74
  v_add_f32 v67, v67, v75
  v_add_f32 v68, v68, v76
  v_add_f32 v69, v69, v77
  v_add_f32 v70, v70, v78
  v_add_f32 v71, v71, v79
  v_add_f32 v64, v64, v68
  v_add_f32 v65, v65, v69
  v_add_f32 v66, v66, v70
  v_add_f32 v67, v67, v71
  v_add_f32 v64, v64, v66
  v_add_f32 v65, v65, v67
  v_cvt_pk_bf16_f32 v64, v64, v65
  buffer_store_dword v64, v44, s[44:47], s66 offen
L_end:
  s_endpgm
.section .rodata,"a"
.p2align 6
.amdhsa_kernel gated_mix__mha_block_cached__glu_gated_geglu__decode_kernel
  .amdhsa_next_free_vgpr 128
  .amdhsa_next_free_sgpr 102
  .amdhsa_accum_offset 128
  .amdhsa_group_segment_fixed_size 0
  .amdhsa_kernarg_size 104
  .amdhsa_user_sgpr_count 2
  .amdhsa_user_sgpr_kernarg_segment_ptr 1
  .amdhsa_system_sgpr_workgroup_id_x 1
  .amdhsa_float_denorm_mode_32 3
.end_amdhsa_kernel
```
